```python
import torch

def _softmax(x, axis=-1):
    return torch.softmax(x, dim=axis)

def _gelu(x):
    return torch.nn.functional.gelu(x, approximate='tanh')

def _silu(x):
    return torch.nn.functional.silu(x)

def _sigmoid(x):
    return torch.sigmoid(x)

def _layernorm(x, axis=-1, eps=1e-05):
    m = x.mean(dim=axis, keepdim=True)
    v = x.var(dim=axis, keepdim=True, unbiased=False)
    return (x - m) / torch.sqrt(v + eps)

def _scatter_add(tgt, idx, src, axis=0):
    return tgt.clone().index_add_(axis, idx, src)

def _segment_sum(src, seg, n):
    out = torch.zeros((n,) + src.shape[1:], dtype=src.dtype)
    return out.index_add_(0, seg, src)

def _pad(x, pw):
    flat = tuple((v for pair in reversed(pw) for v in pair))
    return torch.nn.functional.pad(x, flat)
kernel_name = 'adaLN_cond__ssm_conv_s4__glu_gated_bilinear__prompt'

def setup_inputs():

    _w = lambda a: (lambda t: t.to(torch.bfloat16) if t.is_floating_point() else t)(torch.as_tensor(a))

    def _A_setup():
        B, L, D, N = (1, 2048, 448, 256)
        A_re = -(lambda _x: torch.exp(torch.as_tensor(_x)))((lambda *s: torch.randn(*s, dtype=torch.bfloat16) * 3.2)(D, N))
        A_im = torch.pi * (lambda *s: torch.randn(*s, dtype=torch.bfloat16) * 0.1)(D, N)
        B_re = (lambda *s: torch.randn(*s, dtype=torch.bfloat16) * 0.1)(D, N)
        B_im = (lambda *s: torch.randn(*s, dtype=torch.bfloat16) * 0.1)(D, N)
        C_re = (lambda *s: torch.randn(*s, dtype=torch.bfloat16) * 0.1)(D, N)
        C_im = (lambda *s: torch.randn(*s, dtype=torch.bfloat16) * 0.1)(D, N)
        log_dt = (lambda *s: torch.randn(*s, dtype=torch.bfloat16) * 0.1)(D) * 0.5 - 4.0
        Dskip = (lambda *s: torch.randn(*s, dtype=torch.bfloat16) * 0.1)(D)
        return {'u': _w((lambda *s: torch.randn(*s, dtype=torch.bfloat16) * 0.05)(B, L, D)), 'A_re': _w(A_re), 'A_im': _w(A_im), 'B_re': _w(B_re), 'B_im': _w(B_im), 'C_re': _w(C_re), 'C_im': _w(C_im), 'log_dt': _w(log_dt), 'Dskip': _w(Dskip)}
    _A_in = _A_setup()

    def _B_setup():
        B, S, D, F = (1, 2048, 448, 1792)
        return {'x': _w((lambda *s: torch.randn(*s, dtype=torch.bfloat16) * 0.05)(B, S, D)), 'w_gate': _w((lambda *s: torch.randn(*s, dtype=torch.bfloat16) * 1.6)(D, F) * D ** (-0.5)), 'w_up': _w((lambda *s: torch.randn(*s, dtype=torch.bfloat16) * 1.6)(D, F) * D ** (-0.5)), 'w_down': _w((lambda *s: torch.randn(*s, dtype=torch.bfloat16) * 1.6)(F, D) * F ** (-0.5))}
    _B_in = _B_setup()
    return {'A_u': _A_in['u'], 'A_A_re': _A_in['A_re'], 'A_A_im': _A_in['A_im'], 'A_B_re': _A_in['B_re'], 'A_B_im': _A_in['B_im'], 'A_C_re': _A_in['C_re'], 'A_C_im': _A_in['C_im'], 'A_log_dt': _A_in['log_dt'], 'A_Dskip': _A_in['Dskip'], 'B_x': _B_in['x'], 'B_w_gate': _B_in['w_gate'], 'B_w_up': _B_in['w_up'], 'B_w_down': _B_in['w_down'], 'c': _w((lambda *s: torch.randn(*s, dtype=torch.bfloat16) * 0.2)(1, 448) * 8.0), 'w_mod': _w((lambda *s: torch.randn(*s, dtype=torch.bfloat16) * 0.2)(448, 6 * 448) * 448 ** (-0.5) * 8.0)}

def reference(A_u, A_A_re, A_A_im, A_B_re, A_B_im, A_C_re, A_C_im, A_log_dt, A_Dskip, B_x, B_w_gate, B_w_up, B_w_down, c, w_mod):

    def _A_ref(u, A_re, A_im, B_re, B_im, C_re, C_im, log_dt, Dskip):
        Bsz, L, D = u.shape
        dt = torch.exp(log_dt)[:, None]
        A = A_re + 1j * A_im
        Bc = B_re + 1j * B_im
        Cc = C_re + 1j * C_im
        logdA = dt * A
        dB = dt * Bc
        l = (lambda x, dt: x.to(dt))(torch.arange(L), A_re.dtype)
        P = torch.exp(logdA[:, :, None] * l[None, None, :])
        K = torch.einsum('dn,dnl,dn->dl', Cc, P, dB).real
        L2 = 2 * L
        Kp = _pad(K, ((0, 0), (0, L)))
        up = (lambda x, *d: x.permute(*d))(u, 0, 2, 1)
        up = _pad(up, ((0, 0), (0, 0), (0, L)))
        Kf = (lambda x, axes=(-2, -1): torch.fft.rfft2(x.float(), dim=axes))(Kp[:, None, :], axes=(-2, -1))
        Uf = (lambda x, axes=(-2, -1): torch.fft.rfft2(x.float(), dim=axes))(up[:, :, None, :], axes=(-2, -1))
        Yf = Uf * Kf[None, :, :, :]
        y = (lambda x, s, axes=(-2, -1): torch.fft.irfft2(x, s=s, dim=axes).to(torch.bfloat16))(Yf, (1, L2), axes=(-2, -1))[:, :, 0, :L]
        y = (lambda x, *d: x.permute(*d))(y, 0, 2, 1) + u * Dskip[None, None, :]
        return y

    def _B_ref(x, w_gate, w_up, w_down):
        g = torch.einsum('bsd,df->bsf', x, w_gate)
        u = torch.einsum('bsd,df->bsf', x, w_up)
        h = g * u
        return torch.einsum('bsf,fd->bsd', h, w_down)
    x = A_u
    mod = (_silu(c) @ w_mod).reshape(c.shape[0], 6, 1, -1)
    sa, ca, ga, sb, cb, gb = (mod[:, 0].clone(), mod[:, 1].clone(), mod[:, 2].clone(), mod[:, 3].clone(), mod[:, 4].clone(), mod[:, 5].clone())
    h = _layernorm(x, axis=-1) * (1 + ca) + sa
    x = x + ga * _A_ref(h, A_A_re, A_A_im, A_B_re, A_B_im, A_C_re, A_C_im, A_log_dt, A_Dskip)
    h = _layernorm(x, axis=-1) * (1 + cb) + sb
    x = x + gb * _B_ref(h, B_w_gate, B_w_up, B_w_down)
    return x
```

```asm
; @launch grid=(256,1,1) block=(512,1,1) lds=163840
.amdgcn_target "amdgcn-amd-amdhsa--gfx950"
.text
.globl adaLN_cond__ssm_conv_s4__glu_gated_bilinear__prompt_kernel
.p2align 8
.type adaLN_cond__ssm_conv_s4__glu_gated_bilinear__prompt_kernel,@function
adaLN_cond__ssm_conv_s4__glu_gated_bilinear__prompt_kernel:
    s_cmp_ge_u32 s2, 256
    s_cbranch_scc1 L_end
    s_load_dwordx16 s[16:31], s[0:1], 0
    s_load_dwordx16 s[32:47], s[0:1], 64
    s_load_dwordx4 s[48:51], s[0:1], 128
    v_and_b32 v1, 63, v0
    v_lshrrev_b32 v3, 6, v0
    v_lshlrev_b32 v2, 4, v1
    v_readfirstlane_b32 s3, v3
    s_and_b32 s61, s2, 7
    s_lshr_b32 s62, s2, 3
    s_lshl_b32 s72, s2, 3
    s_add_u32 s72, s72, s3
    s_mul_i32 s73, s72, 896
    s_mov_b32 s58, 896
    s_mov_b32 s59, 0x20000
    s_mov_b32 s54, 268435456
    s_mov_b32 s55, 0x20000
    s_or_b32 s74, s2, s3
    s_cmp_eq_u32 s74, 0
    s_cselect_b32 s74, 4096, s54
    v_lshl_add_u32 v3, v1, 8, s74
    v_mov_b32 v34, 0
    v_mov_b32 v35, 0
    v_mov_b32 v36, 0x3f803f80
    s_waitcnt lgkmcnt(0)
    s_load_dword s60, s[50:51], 0
    s_add_u32 s56, s16, s73
    s_addc_u32 s57, s17, 0
    s_mov_b32 s4, s36
    s_mov_b32 s5, s37
    s_mov_b32 s6, 1605632
    s_mov_b32 s7, 0x20000
    s_mov_b32 s8, s38
    s_mov_b32 s9, s39
    s_mov_b32 s10, 1605632
    s_mov_b32 s11, 0x20000
    s_mov_b32 s52, s50
    s_mov_b32 s53, s51
    buffer_store_dword v34, v3, s[52:55], 0 offen sc1
    buffer_load_dwordx4 v[4:7], v2, s[56:59], 0 offen nt
    s_cmp_ge_u32 s2, 224
    s_cbranch_scc1 L_spare
    s_mul_i32 s66, s61, 28
    s_add_u32 s66, s66, s62
    s_lshl_b32 s63, s66, 1
    s_lshl_b32 s77, s63, 9
    v_lshl_add_u32 v3, v0, 1, s77
    global_load_short_d16_hi v8, v3, s[18:19] nt
    global_load_short_d16_hi v9, v3, s[20:21] nt
    global_load_short_d16_hi v10, v3, s[22:23] nt
    global_load_short_d16_hi v11, v3, s[24:25] nt
    global_load_short_d16_hi v12, v3, s[26:27] nt
    global_load_short_d16_hi v13, v3, s[28:29] nt
    s_lshl_b32 s77, s63, 1
    s_load_dword s67, s[30:31], s77
    s_load_dword s68, s[32:33], s77
    s_and_b32 s77, s61, 1
    s_lshl_b32 s77, s77, 2
    s_lshr_b32 s65, s62, 3
    s_add_u32 s65, s65, s77
    s_and_b32 s64, s62, 7
    s_add_u32 s77, s77, s64
    s_cmp_ge_u32 s62, 24
    s_cselect_b32 s65, 3, s65
    s_cselect_b32 s64, s77, s64
    s_and_b32 s77, s61, 6
    s_lshl_b32 s77, s77, 2
    s_add_u32 s64, s64, s77
    v_and_b32 v52, 255, v0
    v_lshlrev_b32 v52, 3, v52
    v_lshrrev_b32 v53, 8, v0
    v_mul_u32_u24 v53, 3072, v53
    v_add_u32 v53, 43904, v53
    v_add_u32 v100, 7, v52
    v_add_u32 v101, 6, v52
    v_cvt_f32_i32 v54, v100
    v_cvt_f32_i32 v55, v101
    v_cvt_pk_bf16_f32 v54, v54, v55
    v_min_i32 v100, 127, v100
    v_min_i32 v101, 127, v101
    v_lshrrev_b32 v55, 16, v54
    v_and_b32 v54, 0xffff, v54
    v_add_u32 v100, 17024, v100
    v_add_u32 v101, 17024, v101
    v_max_u32 v100, v100, v54
    v_max_u32 v101, v101, v55
    v_lshl_add_u32 v100, v100, 2, v53
    v_lshl_add_u32 v101, v101, 2, v53
    v_add_u32 v102, 5, v52
    v_add_u32 v103, 4, v52
    v_cvt_f32_i32 v54, v102
    v_cvt_f32_i32 v55, v103
    v_cvt_pk_bf16_f32 v54, v54, v55
    v_min_i32 v102, 127, v102
    v_min_i32 v103, 127, v103
    v_lshrrev_b32 v55, 16, v54
    v_and_b32 v54, 0xffff, v54
    v_add_u32 v102, 17024, v102
    v_add_u32 v103, 17024, v103
    v_max_u32 v102, v102, v54
    v_max_u32 v103, v103, v55
    v_lshl_add_u32 v102, v102, 2, v53
    v_lshl_add_u32 v103, v103, 2, v53
    v_add_u32 v104, 3, v52
    v_add_u32 v105, 2, v52
    v_cvt_f32_i32 v54, v104
    v_cvt_f32_i32 v55, v105
    v_cvt_pk_bf16_f32 v54, v54, v55
    v_min_i32 v104, 127, v104
    v_min_i32 v105, 127, v105
    v_lshrrev_b32 v55, 16, v54
    v_and_b32 v54, 0xffff, v54
    v_add_u32 v104, 17024, v104
    v_add_u32 v105, 17024, v105
    v_max_u32 v104, v104, v54
    v_max_u32 v105, v105, v55
    v_lshl_add_u32 v104, v104, 2, v53
    v_lshl_add_u32 v105, v105, 2, v53
    v_add_u32 v106, 1, v52
    v_add_u32 v107, 0, v52
    v_cvt_f32_i32 v54, v106
    v_cvt_f32_i32 v55, v107
    v_cvt_pk_bf16_f32 v54, v54, v55
    v_min_i32 v106, 127, v106
    v_min_i32 v107, 127, v107
    v_lshrrev_b32 v55, 16, v54
    v_and_b32 v54, 0xffff, v54
    v_add_u32 v106, 17024, v106
    v_add_u32 v107, 17024, v107
    v_max_u32 v106, v106, v54
    v_max_u32 v107, v107, v55
    v_lshl_add_u32 v106, v106, 2, v53
    v_lshl_add_u32 v107, v107, 2, v53
    s_and_b32 s80, s3, 3
    v_add_u32 v53, 68096, v53
    s_mov_b32 s81, 100666364
    s_cmp_ge_u32 s80, 2
    s_cselect_b32 s81, 150996992, s81
    s_bitcmp1_b32 s80, 0
    s_cselect_b32 s82, 16, 0
    s_lshr_b32 s81, s81, s82
    s_and_b32 s81, s81, 0xffff
    v_add_u32 v108, s81, v53
    s_mov_b32 s81, 100404220
    s_cmp_ge_u32 s80, 2
    s_cselect_b32 s81, 150996992, s81
    s_bitcmp1_b32 s80, 0
    s_cselect_b32 s82, 16, 0
    s_lshr_b32 s81, s81, s82
    s_and_b32 s81, s81, 0xffff
    v_add_u32 v109, s81, v53
    s_mov_b32 s81, 100142076
    s_cmp_ge_u32 s80, 2
    s_cselect_b32 s81, 150996988, s81
    s_bitcmp1_b32 s80, 0
    s_cselect_b32 s82, 16, 0
    s_lshr_b32 s81, s81, s82
    s_and_b32 s81, s81, 0xffff
    v_add_u32 v110, s81, v53
    s_mov_b32 s81, 100142076
    s_cmp_ge_u32 s80, 2
    s_cselect_b32 s81, 150996988, s81
    s_bitcmp1_b32 s80, 0
    s_cselect_b32 s82, 16, 0
    s_lshr_b32 s81, s81, s82
    s_and_b32 s81, s81, 0xffff
    v_add_u32 v111, s81, v53
    s_mov_b32 s81, 100142076
    s_cmp_ge_u32 s80, 2
    s_cselect_b32 s81, 150734844, s81
    s_bitcmp1_b32 s80, 0
    s_cselect_b32 s82, 16, 0
    s_lshr_b32 s81, s81, s82
    s_and_b32 s81, s81, 0xffff
    v_add_u32 v112, s81, v53
    s_mov_b32 s81, 99879932
    s_cmp_ge_u32 s80, 2
    s_cselect_b32 s81, 150734840, s81
    s_bitcmp1_b32 s80, 0
    s_cselect_b32 s82, 16, 0
    s_lshr_b32 s81, s81, s82
    s_and_b32 s81, s81, 0xffff
    v_add_u32 v113, s81, v53
    s_mov_b32 s81, 99617788
    s_cmp_ge_u32 s80, 2
    s_cselect_b32 s81, 150734840, s81
    s_bitcmp1_b32 s80, 0
    s_cselect_b32 s82, 16, 0
    s_lshr_b32 s81, s81, s82
    s_and_b32 s81, s81, 0xffff
    v_add_u32 v114, s81, v53
    s_mul_i32 s75, s3, 912
    s_add_u32 s75, s75, 120064
    v_add_u32 v37, s75, v2
    v_lshrrev_b32 v38, 2, v0
    v_and_b32 v39, 3, v0
    v_mul_u32_u24 v14, 1824, v39
    v_lshl_add_u32 v14, v38, 2, v14
    v_add_u32 v14, 120064, v14
    v_lshlrev_b32 v38, 14, v38
    v_lshl_add_u32 v38, v39, 4, v38
    s_cmp_ge_u32 s3, 6
    s_cselect_b32 s75, s54, 2097152
    v_add_u32 v39, s75, v38
    s_lshl_b32 s76, s2, 6
    s_add_u32 s76, s76, 10092544
    s_lshl_b32 s75, s72, 3
    s_add_u32 s75, s75, 32768
    s_waitcnt lgkmcnt(0)
    s_add_u32 s60, s60, 1
    s_lshl_b32 s81, s67, 16
    s_and_b32 s82, s67, 0xffff0000
    s_lshl_b32 s83, s68, 16
    s_and_b32 s68, s68, 0xffff0000
    s_cmp_ge_u32 s3, 4
    s_cselect_b32 s81, s82, s81
    s_cselect_b32 s68, s68, s83
    v_mov_b32 v60, 0x3fb8aa3b
    v_mul_f32 v60, s81, v60
    s_cselect_b32 s81, 55968, 0
    v_exp_f32 v60, v60
    s_and_b32 s82, s3, 3
    s_lshl_b32 s82, s82, 8
    s_add_u32 m0, s82, s81
    v_cvt_pk_bf16_f32 v60, v60, v60
    v_lshlrev_b32 v60, 16, v60
    s_waitcnt vmcnt(5)
    v_mul_f32 v61, v60, v8
    s_waitcnt vmcnt(4)
    v_mul_f32 v62, v60, v9
    v_mul_f32 v61, 0x3fb8aa3b, v61
    v_mul_f32 v62, 0x3e22f983, v62
    s_waitcnt vmcnt(3)
    v_mul_f32 v10, v60, v10
    s_waitcnt vmcnt(2)
    v_mul_f32 v11, v60, v11
    v_mul_f32 v86, 0x41000000, v61
    v_mul_f32 v87, 0x41000000, v62
    v_mul_f32 v88, 0x3f800000, v61
    v_mul_f32 v89, 0x3f800000, v62
    v_mul_f32 v90, 0x43800000, v61
    v_mul_f32 v91, 0x43800000, v62
    v_exp_f32 v86, v86
    v_fract_f32 v87, v87
    v_exp_f32 v88, v88
    v_fract_f32 v89, v89
    v_exp_f32 v90, v90
    v_fract_f32 v91, v91
    s_waitcnt vmcnt(1)
    v_mul_f32 v64, v12, v10
    v_mul_f32 v65, v12, v11
    v_cos_f32 v72, v87
    v_sin_f32 v73, v87
    v_cos_f32 v66, v89
    v_sin_f32 v67, v89
    v_cos_f32 v76, v91
    v_sin_f32 v77, v91
    s_waitcnt vmcnt(0)
    v_fma_f32 v64, -v13, v11, v64
    v_fma_f32 v65, v13, v10, v65
    v_pk_mul_f32 v[72:73], v[72:73], v[86:87] op_sel_hi:[1,0]
    v_pk_mul_f32 v[66:67], v[66:67], v[88:89] op_sel_hi:[1,0]
    v_pk_mul_f32 v[76:77], v[76:77], v[90:91] op_sel_hi:[1,0]
    v_pk_mul_f32 v[86:87], v[72:73], v[72:73] op_sel_hi:[0,1]
    v_pk_fma_f32 v[74:75], v[72:73], v[72:73], v[86:87] op_sel:[1,1,0] op_sel_hi:[1,0,1] neg_lo:[1,0,0]
    v_pk_mul_f32 v[88:89], v[66:67], v[66:67] op_sel_hi:[0,1]
    v_pk_fma_f32 v[68:69], v[66:67], v[66:67], v[88:89] op_sel:[1,1,0] op_sel_hi:[1,0,1] neg_lo:[1,0,0]
    v_pk_mul_f32 v[88:89], v[68:69], v[68:69] op_sel_hi:[0,1]
    v_pk_fma_f32 v[70:71], v[68:69], v[68:69], v[88:89] op_sel:[1,1,0] op_sel_hi:[1,0,1] neg_lo:[1,0,0]
    s_cmp_lt_u32 s3, 4
    s_cbranch_scc1 L_pr1
    s_setprio 1
L_pr1:
    v_cvt_pk_bf16_f32 v92, v64, -v65
    v_mov_b32 v98, 0x3f80
    v_cvt_pk_bf16_f32 v96, v72, v73
    s_mov_b32 exec_hi, 0x00ffffff
    ds_write_b128 v37, v[4:7]
    s_mov_b32 exec_hi, -1
    ds_write_addtid_b32 v92 offset:0
    ds_write_addtid_b32 v98 offset:22176
    ds_write_addtid_b32 v96 offset:23232
    v_dot2c_f32_bf16 v34, v4, v36
    v_pk_mul_f32 v[86:87], v[64:65], v[66:67] op_sel_hi:[0,1]
    v_cvt_pk_bf16_f32 v94, v74, v75
    v_pk_mul_f32 v[90:91], v[72:73], v[74:75] op_sel_hi:[0,1]
    v_dot2c_f32_bf16 v35, v4, v4
    v_pk_fma_f32 v[78:79], v[64:65], v[66:67], v[86:87] op_sel:[1,1,0] op_sel_hi:[1,0,1] neg_lo:[1,0,0]
    v_dot2c_f32_bf16 v34, v5, v36
    v_cvt_pk_bf16_f32 v93, v78, -v79
    ds_write_addtid_b32 v94 offset:24288
    v_pk_fma_f32 v[82:83], v[72:73], v[74:75], v[90:91] op_sel:[1,1,0] op_sel_hi:[1,0,1] neg_lo:[1,0,0]
    v_dot2c_f32_bf16 v35, v5, v5
    ds_write_addtid_b32 v93 offset:1056
    v_pk_mul_f32 v[88:89], v[74:75], v[74:75] op_sel_hi:[0,1]
    v_cvt_pk_bf16_f32 v97, v82, v83
    v_dot2c_f32_bf16 v34, v6, v36
    v_pk_mul_f32 v[86:87], v[78:79], v[66:67] op_sel_hi:[0,1]
    v_pk_fma_f32 v[80:81], v[74:75], v[74:75], v[88:89] op_sel:[1,1,0] op_sel_hi:[1,0,1] neg_lo:[1,0,0]
    ds_write_addtid_b32 v97 offset:25344
    v_dot2c_f32_bf16 v35, v6, v6
    v_pk_fma_f32 v[78:79], v[78:79], v[66:67], v[86:87] op_sel:[1,1,0] op_sel_hi:[1,0,1] neg_lo:[1,0,0]
    v_dot2c_f32_bf16 v34, v7, v36
    v_cvt_pk_bf16_f32 v92, v78, -v79
    v_cvt_pk_bf16_f32 v95, v80, v81
    v_pk_mul_f32 v[90:91], v[82:83], v[74:75] op_sel_hi:[0,1]
    v_dot2c_f32_bf16 v35, v7, v7
    ds_write_addtid_b32 v92 offset:2112
    ds_write_addtid_b32 v95 offset:26400
    v_pk_fma_f32 v[82:83], v[82:83], v[74:75], v[90:91] op_sel:[1,1,0] op_sel_hi:[1,0,1] neg_lo:[1,0,0]
    v_mov_b32 v5, s60
    v_pk_mul_f32 v[86:87], v[78:79], v[66:67] op_sel_hi:[0,1]
    v_pk_mul_f32 v[88:89], v[80:81], v[74:75] op_sel_hi:[0,1]
    v_cvt_pk_bf16_f32 v96, v82, v83
    v_mov_b32 v7, s60
    v_pk_fma_f32 v[78:79], v[78:79], v[66:67], v[86:87] op_sel:[1,1,0] op_sel_hi:[1,0,1] neg_lo:[1,0,0]
    v_mov_b32 v17, s60
    v_cvt_pk_bf16_f32 v93, v78, -v79
    v_pk_fma_f32 v[80:81], v[80:81], v[74:75], v[88:89] op_sel:[1,1,0] op_sel_hi:[1,0,1] neg_lo:[1,0,0]
    ds_write_addtid_b32 v96 offset:27456
    v_mov_b32 v19, s60
    ds_write_addtid_b32 v93 offset:3168
    v_cvt_pk_bf16_f32 v94, v80, v81
    v_pk_mul_f32 v[90:91], v[82:83], v[74:75] op_sel_hi:[0,1]
    s_cmp_ge_u32 s3, 4
    s_cbranch_scc0 L_xga
    s_waitcnt lgkmcnt(0)
    s_barrier
    ds_read_b32 v4, v14
    ds_read_b32 v6, v14 offset:912
    ds_read_b32 v16, v14 offset:512
    ds_read_b32 v18, v14 offset:1424
    s_waitcnt lgkmcnt(2)
    buffer_store_dwordx4 v[4:7], v38, s[52:55], s76 offen sc1
    s_waitcnt lgkmcnt(0)
    buffer_store_dwordx4 v[16:19], v39, s[52:55], s76 offen sc1
L_xga:
    v_pk_mul_f32 v[86:87], v[78:79], v[66:67] op_sel_hi:[0,1]
    ds_write_addtid_b32 v94 offset:28512
    v_pk_fma_f32 v[82:83], v[82:83], v[74:75], v[90:91] op_sel:[1,1,0] op_sel_hi:[1,0,1] neg_lo:[1,0,0]
    v_add_f32_dpp v34, v34, v34 row_shr:1 row_mask:0xf bank_mask:0xf
    v_pk_fma_f32 v[78:79], v[78:79], v[66:67], v[86:87] op_sel:[1,1,0] op_sel_hi:[1,0,1] neg_lo:[1,0,0]
    v_add_f32_dpp v35, v35, v35 row_shr:1 row_mask:0xf bank_mask:0xf
    v_cvt_pk_bf16_f32 v92, v78, -v79
    v_pk_mul_f32 v[88:89], v[80:81], v[74:75] op_sel_hi:[0,1]
    v_cvt_pk_bf16_f32 v97, v82, v83
    v_add_f32_dpp v34, v34, v34 row_shr:2 row_mask:0xf bank_mask:0xf
    ds_write_addtid_b32 v92 offset:4224
    v_pk_fma_f32 v[80:81], v[80:81], v[74:75], v[88:89] op_sel:[1,1,0] op_sel_hi:[1,0,1] neg_lo:[1,0,0]
    ds_write_addtid_b32 v97 offset:29568
    v_add_f32_dpp v35, v35, v35 row_shr:2 row_mask:0xf bank_mask:0xf
    v_pk_mul_f32 v[86:87], v[78:79], v[66:67] op_sel_hi:[0,1]
    v_cvt_pk_bf16_f32 v95, v80, v81
    v_pk_mul_f32 v[90:91], v[82:83], v[74:75] op_sel_hi:[0,1]
    v_add_f32_dpp v34, v34, v34 row_shr:4 row_mask:0xf bank_mask:0xf
    v_pk_fma_f32 v[78:79], v[78:79], v[66:67], v[86:87] op_sel:[1,1,0] op_sel_hi:[1,0,1] neg_lo:[1,0,0]
    v_add_f32_dpp v35, v35, v35 row_shr:4 row_mask:0xf bank_mask:0xf
    v_cvt_pk_bf16_f32 v93, v78, -v79
    ds_write_addtid_b32 v95 offset:30624
    v_pk_fma_f32 v[82:83], v[82:83], v[74:75], v[90:91] op_sel:[1,1,0] op_sel_hi:[1,0,1] neg_lo:[1,0,0]
    v_add_f32_dpp v34, v34, v34 row_shr:8 row_mask:0xf bank_mask:0xf
    ds_write_addtid_b32 v93 offset:5280
    v_pk_mul_f32 v[88:89], v[80:81], v[74:75] op_sel_hi:[0,1]
    v_cvt_pk_bf16_f32 v96, v82, v83
    v_add_f32_dpp v35, v35, v35 row_shr:8 row_mask:0xf bank_mask:0xf
    v_pk_mul_f32 v[86:87], v[78:79], v[66:67] op_sel_hi:[0,1]
    v_pk_fma_f32 v[80:81], v[80:81], v[74:75], v[88:89] op_sel:[1,1,0] op_sel_hi:[1,0,1] neg_lo:[1,0,0]
    ds_write_addtid_b32 v96 offset:31680
    v_add_f32_dpp v34, v34, v34 row_bcast:15 row_mask:0xa bank_mask:0xf
    v_pk_fma_f32 v[78:79], v[78:79], v[66:67], v[86:87] op_sel:[1,1,0] op_sel_hi:[1,0,1] neg_lo:[1,0,0]
    v_add_f32_dpp v35, v35, v35 row_bcast:15 row_mask:0xa bank_mask:0xf
    v_cvt_pk_bf16_f32 v92, v78, -v79
    v_cvt_pk_bf16_f32 v94, v80, v81
    v_pk_mul_f32 v[90:91], v[82:83], v[74:75] op_sel_hi:[0,1]
    v_add_f32_dpp v34, v34, v34 row_bcast:31 row_mask:0xc bank_mask:0xf
    ds_write_addtid_b32 v92 offset:6336
    ds_write_addtid_b32 v94 offset:32736
    v_pk_fma_f32 v[82:83], v[82:83], v[74:75], v[90:91] op_sel:[1,1,0] op_sel_hi:[1,0,1] neg_lo:[1,0,0]
    v_add_f32_dpp v35, v35, v35 row_bcast:31 row_mask:0xc bank_mask:0xf
    v_pk_mul_f32 v[86:87], v[78:79], v[66:67] op_sel_hi:[0,1]
    v_pk_mul_f32 v[88:89], v[80:81], v[74:75] op_sel_hi:[0,1]
    v_cvt_pk_bf16_f32 v97, v82, v83
    v_mul_f32 v34, 0x3b124925, v34
    v_pk_fma_f32 v[78:79], v[78:79], v[66:67], v[86:87] op_sel:[1,1,0] op_sel_hi:[1,0,1] neg_lo:[1,0,0]
    v_mul_f32 v35, 0x3b124925, v35
    v_cvt_pk_bf16_f32 v93, v78, -v79
    v_pk_fma_f32 v[80:81], v[80:81], v[74:75], v[88:89] op_sel:[1,1,0] op_sel_hi:[1,0,1] neg_lo:[1,0,0]
    ds_write_addtid_b32 v97 offset:33792
    v_fma_f32 v35, -v34, v34, v35
    ds_write_addtid_b32 v93 offset:7392
    v_cvt_pk_bf16_f32 v95, v80, v81
    v_pk_mul_f32 v[90:91], v[82:83], v[74:75] op_sel_hi:[0,1]
    v_max_f32 v35, 0, v35
    v_pk_mul_f32 v[86:87], v[64:65], v[76:77] op_sel_hi:[0,1]
    ds_write_addtid_b32 v95 offset:34848
    v_pk_fma_f32 v[82:83], v[82:83], v[74:75], v[90:91] op_sel:[1,1,0] op_sel_hi:[1,0,1] neg_lo:[1,0,0]
    v_cvt_pk_bf16_f32 v35, v35, v35
    v_pk_fma_f32 v[78:79], v[64:65], v[76:77], v[86:87] op_sel:[1,1,0] op_sel_hi:[1,0,1] neg_lo:[1,0,0]
    v_lshlrev_b32 v35, 16, v35
    v_cvt_pk_bf16_f32 v92, v78, -v79
    v_pk_mul_f32 v[88:89], v[80:81], v[74:75] op_sel_hi:[0,1]
    v_cvt_pk_bf16_f32 v96, v82, v83
    v_add_f32 v35, 0x3727c5ac, v35
    ds_write_addtid_b32 v92 offset:8448
    v_pk_fma_f32 v[80:81], v[80:81], v[74:75], v[88:89] op_sel:[1,1,0] op_sel_hi:[1,0,1] neg_lo:[1,0,0]
    ds_write_addtid_b32 v96 offset:35904
    v_cvt_pk_bf16_f32 v35, v35, v35
    v_pk_mul_f32 v[86:87], v[78:79], v[68:69] op_sel_hi:[0,1]
    v_cvt_pk_bf16_f32 v94, v80, v81
    v_pk_mul_f32 v[90:91], v[82:83], v[74:75] op_sel_hi:[0,1]
    v_lshlrev_b32 v35, 16, v35
    v_pk_fma_f32 v[84:85], v[78:79], v[68:69], v[86:87] op_sel:[1,1,0] op_sel_hi:[1,0,1] neg_lo:[1,0,0]
    v_sqrt_f32 v35, v35
    v_cvt_pk_bf16_f32 v93, v84, -v85
    ds_write_addtid_b32 v94 offset:36960
    v_pk_fma_f32 v[82:83], v[82:83], v[74:75], v[90:91] op_sel:[1,1,0] op_sel_hi:[1,0,1] neg_lo:[1,0,0]
    v_mov_b32 v36, 0
    ds_write_addtid_b32 v93 offset:9504
    v_pk_mul_f32 v[88:89], v[80:81], v[74:75] op_sel_hi:[0,1]
    v_cvt_pk_bf16_f32 v97, v82, v83
    v_cvt_pk_bf16_f32 v34, v34, v35
    v_pk_mul_f32 v[86:87], v[84:85], v[68:69] op_sel_hi:[0,1]
    v_pk_fma_f32 v[80:81], v[80:81], v[74:75], v[88:89] op_sel:[1,1,0] op_sel_hi:[1,0,1] neg_lo:[1,0,0]
    ds_write_addtid_b32 v97 offset:38016
    v_mov_b32 v35, s60
    v_pk_fma_f32 v[84:85], v[84:85], v[68:69], v[86:87] op_sel:[1,1,0] op_sel_hi:[1,0,1] neg_lo:[1,0,0]
    s_cmp_lt_u32 s3, 4
    s_cbranch_scc0 L_xgb
    s_waitcnt lgkmcnt(0)
    s_barrier
    ds_read_b32 v4, v14
    ds_read_b32 v6, v14 offset:912
    ds_read_b32 v16, v14 offset:512
    ds_read_b32 v18, v14 offset:1424
    s_waitcnt lgkmcnt(2)
    buffer_store_dwordx4 v[4:7], v38, s[52:55], s76 offen sc1
    s_waitcnt lgkmcnt(0)
    buffer_store_dwordx4 v[16:19], v39, s[52:55], s76 offen sc1
L_xgb:
    s_mov_b32 exec_lo, 0
    s_mov_b32 exec_hi, 0x80000000
    buffer_store_dwordx2 v[34:35], v36, s[52:55], s75 offen sc1
    s_mov_b64 exec, -1
    v_cvt_pk_bf16_f32 v92, v84, -v85
    v_cvt_pk_bf16_f32 v95, v80, v81
    v_pk_mul_f32 v[90:91], v[82:83], v[74:75] op_sel_hi:[0,1]
    ds_write_addtid_b32 v92 offset:10560
    ds_write_addtid_b32 v95 offset:39072
    v_pk_fma_f32 v[82:83], v[82:83], v[74:75], v[90:91] op_sel:[1,1,0] op_sel_hi:[1,0,1] neg_lo:[1,0,0]
    v_pk_mul_f32 v[86:87], v[84:85], v[68:69] op_sel_hi:[0,1]
    v_pk_mul_f32 v[88:89], v[80:81], v[74:75] op_sel_hi:[0,1]
    v_cvt_pk_bf16_f32 v96, v82, v83
    v_pk_fma_f32 v[84:85], v[84:85], v[68:69], v[86:87] op_sel:[1,1,0] op_sel_hi:[1,0,1] neg_lo:[1,0,0]
    v_cvt_pk_bf16_f32 v93, v84, -v85
    v_pk_fma_f32 v[80:81], v[80:81], v[74:75], v[88:89] op_sel:[1,1,0] op_sel_hi:[1,0,1] neg_lo:[1,0,0]
    ds_write_addtid_b32 v96 offset:40128
    ds_write_addtid_b32 v93 offset:11616
    v_cvt_pk_bf16_f32 v94, v80, v81
    v_pk_mul_f32 v[90:91], v[82:83], v[74:75] op_sel_hi:[0,1]
    v_pk_mul_f32 v[86:87], v[78:79], v[76:77] op_sel_hi:[0,1]
    ds_write_addtid_b32 v94 offset:41184
    v_pk_fma_f32 v[82:83], v[82:83], v[74:75], v[90:91] op_sel:[1,1,0] op_sel_hi:[1,0,1] neg_lo:[1,0,0]
    v_pk_fma_f32 v[78:79], v[78:79], v[76:77], v[86:87] op_sel:[1,1,0] op_sel_hi:[1,0,1] neg_lo:[1,0,0]
    v_cvt_pk_bf16_f32 v92, v78, -v79
    v_pk_mul_f32 v[88:89], v[80:81], v[74:75] op_sel_hi:[0,1]
    v_cvt_pk_bf16_f32 v97, v82, v83
    ds_write_addtid_b32 v92 offset:12672
    v_pk_fma_f32 v[80:81], v[80:81], v[74:75], v[88:89] op_sel:[1,1,0] op_sel_hi:[1,0,1] neg_lo:[1,0,0]
    ds_write_addtid_b32 v97 offset:42240
    v_pk_mul_f32 v[86:87], v[78:79], v[70:71] op_sel_hi:[0,1]
    v_cvt_pk_bf16_f32 v95, v80, v81
    v_pk_mul_f32 v[90:91], v[82:83], v[74:75] op_sel_hi:[0,1]
    v_pk_fma_f32 v[84:85], v[78:79], v[70:71], v[86:87] op_sel:[1,1,0] op_sel_hi:[1,0,1] neg_lo:[1,0,0]
    v_cvt_pk_bf16_f32 v93, v84, -v85
    ds_write_addtid_b32 v95 offset:43296
    v_pk_fma_f32 v[82:83], v[82:83], v[74:75], v[90:91] op_sel:[1,1,0] op_sel_hi:[1,0,1] neg_lo:[1,0,0]
    ds_write_addtid_b32 v93 offset:13728
    v_pk_mul_f32 v[88:89], v[80:81], v[74:75] op_sel_hi:[0,1]
    v_cvt_pk_bf16_f32 v96, v82, v83
    v_pk_mul_f32 v[86:87], v[78:79], v[76:77] op_sel_hi:[0,1]
    v_pk_fma_f32 v[80:81], v[80:81], v[74:75], v[88:89] op_sel:[1,1,0] op_sel_hi:[1,0,1] neg_lo:[1,0,0]
    ds_write_addtid_b32 v96 offset:44352
    v_pk_fma_f32 v[78:79], v[78:79], v[76:77], v[86:87] op_sel:[1,1,0] op_sel_hi:[1,0,1] neg_lo:[1,0,0]
    v_cvt_pk_bf16_f32 v92, v78, -v79
    v_cvt_pk_bf16_f32 v94, v80, v81
    v_pk_mul_f32 v[90:91], v[82:83], v[74:75] op_sel_hi:[0,1]
    ds_write_addtid_b32 v92 offset:14784
    ds_write_addtid_b32 v94 offset:45408
    v_pk_fma_f32 v[82:83], v[82:83], v[74:75], v[90:91] op_sel:[1,1,0] op_sel_hi:[1,0,1] neg_lo:[1,0,0]
    v_pk_mul_f32 v[86:87], v[78:79], v[70:71] op_sel_hi:[0,1]
    v_pk_mul_f32 v[88:89], v[80:81], v[74:75] op_sel_hi:[0,1]
    v_cvt_pk_bf16_f32 v97, v82, v83
    v_pk_fma_f32 v[84:85], v[78:79], v[70:71], v[86:87] op_sel:[1,1,0] op_sel_hi:[1,0,1] neg_lo:[1,0,0]
    v_cvt_pk_bf16_f32 v93, v84, -v85
    v_pk_fma_f32 v[80:81], v[80:81], v[74:75], v[88:89] op_sel:[1,1,0] op_sel_hi:[1,0,1] neg_lo:[1,0,0]
    ds_write_addtid_b32 v97 offset:46464
    ds_write_addtid_b32 v93 offset:15840
    v_cvt_pk_bf16_f32 v95, v80, v81
    v_pk_mul_f32 v[90:91], v[82:83], v[74:75] op_sel_hi:[0,1]
    v_pk_mul_f32 v[86:87], v[78:79], v[76:77] op_sel_hi:[0,1]
    ds_write_addtid_b32 v95 offset:47520
    v_pk_fma_f32 v[82:83], v[82:83], v[74:75], v[90:91] op_sel:[1,1,0] op_sel_hi:[1,0,1] neg_lo:[1,0,0]
    v_pk_fma_f32 v[78:79], v[78:79], v[76:77], v[86:87] op_sel:[1,1,0] op_sel_hi:[1,0,1] neg_lo:[1,0,0]
    v_cvt_pk_bf16_f32 v92, v78, -v79
    v_pk_mul_f32 v[88:89], v[80:81], v[74:75] op_sel_hi:[0,1]
    v_cvt_pk_bf16_f32 v96, v82, v83
    ds_write_addtid_b32 v92 offset:16896
    v_pk_fma_f32 v[80:81], v[80:81], v[74:75], v[88:89] op_sel:[1,1,0] op_sel_hi:[1,0,1] neg_lo:[1,0,0]
    ds_write_addtid_b32 v96 offset:48576
    v_pk_mul_f32 v[86:87], v[78:79], v[76:77] op_sel_hi:[0,1]
    v_cvt_pk_bf16_f32 v94, v80, v81
    v_pk_mul_f32 v[90:91], v[82:83], v[74:75] op_sel_hi:[0,1]
    v_pk_fma_f32 v[78:79], v[78:79], v[76:77], v[86:87] op_sel:[1,1,0] op_sel_hi:[1,0,1] neg_lo:[1,0,0]
    v_cvt_pk_bf16_f32 v93, v78, -v79
    ds_write_addtid_b32 v94 offset:49632
    v_pk_fma_f32 v[82:83], v[82:83], v[74:75], v[90:91] op_sel:[1,1,0] op_sel_hi:[1,0,1] neg_lo:[1,0,0]
    ds_write_addtid_b32 v93 offset:17952
    v_pk_mul_f32 v[88:89], v[80:81], v[74:75] op_sel_hi:[0,1]
    v_cvt_pk_bf16_f32 v97, v82, v83
    v_pk_mul_f32 v[86:87], v[78:79], v[76:77] op_sel_hi:[0,1]
    v_pk_fma_f32 v[80:81], v[80:81], v[74:75], v[88:89] op_sel:[1,1,0] op_sel_hi:[1,0,1] neg_lo:[1,0,0]
    ds_write_addtid_b32 v97 offset:50688
    v_pk_fma_f32 v[78:79], v[78:79], v[76:77], v[86:87] op_sel:[1,1,0] op_sel_hi:[1,0,1] neg_lo:[1,0,0]
    v_cvt_pk_bf16_f32 v92, v78, -v79
    v_cvt_pk_bf16_f32 v95, v80, v81
    v_pk_mul_f32 v[90:91], v[82:83], v[74:75] op_sel_hi:[0,1]
    ds_write_addtid_b32 v92 offset:19008
    ds_write_addtid_b32 v95 offset:51744
    v_pk_fma_f32 v[82:83], v[82:83], v[74:75], v[90:91] op_sel:[1,1,0] op_sel_hi:[1,0,1] neg_lo:[1,0,0]
    v_pk_mul_f32 v[86:87], v[78:79], v[76:77] op_sel_hi:[0,1]
    v_pk_mul_f32 v[88:89], v[80:81], v[74:75] op_sel_hi:[0,1]
    v_cvt_pk_bf16_f32 v96, v82, v83
    v_pk_fma_f32 v[78:79], v[78:79], v[76:77], v[86:87] op_sel:[1,1,0] op_sel_hi:[1,0,1] neg_lo:[1,0,0]
    v_cvt_pk_bf16_f32 v93, v78, -v79
    v_pk_fma_f32 v[80:81], v[80:81], v[74:75], v[88:89] op_sel:[1,1,0] op_sel_hi:[1,0,1] neg_lo:[1,0,0]
    ds_write_addtid_b32 v96 offset:52800
    ds_write_addtid_b32 v93 offset:20064
    v_cvt_pk_bf16_f32 v94, v80, v81
    v_pk_mul_f32 v[90:91], v[82:83], v[74:75] op_sel_hi:[0,1]
    v_pk_mul_f32 v[86:87], v[78:79], v[76:77] op_sel_hi:[0,1]
    ds_write_addtid_b32 v94 offset:53856
    v_pk_fma_f32 v[82:83], v[82:83], v[74:75], v[90:91] op_sel:[1,1,0] op_sel_hi:[1,0,1] neg_lo:[1,0,0]
    v_pk_fma_f32 v[78:79], v[78:79], v[76:77], v[86:87] op_sel:[1,1,0] op_sel_hi:[1,0,1] neg_lo:[1,0,0]
    v_cvt_pk_bf16_f32 v92, v78, -v79
    v_cvt_pk_bf16_f32 v97, v82, v83
    ds_write_addtid_b32 v92 offset:21120
    ds_write_addtid_b32 v97 offset:54912
    s_bfe_u32 s82, s3, 0x10001
    s_and_b32 s83, s3, 1
    s_mul_i32 s84, s82, 16896
    s_add_u32 s84, s84, s81
    s_mul_i32 s85, s83, 16896
    s_add_u32 s85, s85, s81
    s_add_u32 s85, s85, 22176
    v_and_b32 v40, 15, v1
    v_lshrrev_b32 v41, 4, v1
    v_mul_u32_u24 v42, 1056, v40
    v_lshl_add_u32 v42, v41, 4, v42
    v_add_u32 v43, s85, v42
    v_add_u32 v42, s84, v42
    s_setprio 0
    s_waitcnt lgkmcnt(0)
    s_barrier
    ds_read_b128 v[128:131], v42 offset:0
    ds_read_b128 v[132:135], v43 offset:0
    ds_read_b128 v[136:139], v42 offset:64
    ds_read_b128 v[140:143], v43 offset:64
    ds_read_b128 v[144:147], v42 offset:128
    ds_read_b128 v[148:151], v43 offset:128
    ds_read_b128 v[152:155], v42 offset:192
    ds_read_b128 v[156:159], v43 offset:192
    ds_read_b128 v[160:163], v42 offset:256
    ds_read_b128 v[164:167], v43 offset:256
    ds_read_b128 v[168:171], v42 offset:320
    ds_read_b128 v[172:175], v43 offset:320
    s_lshl_b32 s83, s83, 4
    v_add_u32 v44, s83, v40
    s_cmp_ge_u32 s3, 4
    s_cselect_b32 s84, 3072, 0
    s_add_u32 s84, s84, 112000
    s_waitcnt lgkmcnt(10)
    v_mfma_f32_16x16x32_bf16 v[120:123], v[128:131], v[132:135], 0
    ds_read_b128 v[176:179], v42 offset:384
    ds_read_b128 v[180:183], v43 offset:384
    v_lshlrev_b32 v45, 3, v44
    v_lshl_add_u32 v45, v41, 2, v45
    s_waitcnt lgkmcnt(10)
    v_mfma_f32_16x16x32_bf16 v[120:123], v[136:139], v[140:143], v[120:123]
    ds_read_b128 v[184:187], v42 offset:448
    ds_read_b128 v[188:191], v43 offset:448
    v_lshlrev_b32 v46, 2, v44
    v_add_u32 v46, 256, v46
    s_waitcnt lgkmcnt(10)
    v_mfma_f32_16x16x32_bf16 v[120:123], v[144:147], v[148:151], v[120:123]
    ds_read_b128 v[128:131], v42 offset:512
    ds_read_b128 v[132:135], v43 offset:512
    v_cmp_eq_u32 vcc, 2, v41
    v_lshlrev_b32 v47, 1, v44
    s_waitcnt lgkmcnt(10)
    v_mfma_f32_16x16x32_bf16 v[120:123], v[152:155], v[156:159], v[120:123]
    ds_read_b128 v[136:139], v42 offset:576
    ds_read_b128 v[140:143], v43 offset:576
    v_add_u32 v48, 384, v47
    v_cndmask_b32 v45, v45, v46, vcc
    s_waitcnt lgkmcnt(10)
    v_mfma_f32_16x16x32_bf16 v[120:123], v[160:163], v[164:167], v[120:123]
    ds_read_b128 v[144:147], v42 offset:640
    ds_read_b128 v[148:151], v43 offset:640
    v_add_u32 v46, 2, v45
    v_cmp_eq_u32 vcc, 3, v41
    s_waitcnt lgkmcnt(10)
    v_mfma_f32_16x16x32_bf16 v[120:123], v[168:171], v[172:175], v[120:123]
    ds_read_b128 v[152:155], v42 offset:704
    ds_read_b128 v[156:159], v43 offset:704
    v_add_u32 v47, 448, v47
    v_mov_b32 v52, 0
    s_waitcnt lgkmcnt(10)
    v_mfma_f32_16x16x32_bf16 v[120:123], v[176:179], v[180:183], v[120:123]
    ds_read_b128 v[160:163], v42 offset:768
    ds_read_b128 v[164:167], v43 offset:768
    v_cndmask_b32 v45, v45, v48, vcc
    v_cndmask_b32 v46, v46, v47, vcc
    s_waitcnt lgkmcnt(10)
    v_mfma_f32_16x16x32_bf16 v[120:123], v[184:187], v[188:191], v[120:123]
    ds_read_b128 v[168:171], v42 offset:832
    ds_read_b128 v[172:175], v43 offset:832
    v_lshl_add_u32 v45, v45, 2, s84
    v_lshl_add_u32 v46, v46, 2, s84
    s_waitcnt lgkmcnt(10)
    v_mfma_f32_16x16x32_bf16 v[120:123], v[128:131], v[132:135], v[120:123]
    ds_read_b128 v[176:179], v42 offset:896
    ds_read_b128 v[180:183], v43 offset:896
    v_lshlrev_b32 v47, 7, v41
    v_add_u32 v47, v47, v44
    s_waitcnt lgkmcnt(10)
    v_mfma_f32_16x16x32_bf16 v[120:123], v[136:139], v[140:143], v[120:123]
    ds_read_b128 v[184:187], v42 offset:960
    ds_read_b128 v[188:191], v43 offset:960
    v_add_u32 v47, 512, v47
    v_lshl_add_u32 v47, v47, 2, s84
    s_waitcnt lgkmcnt(10)
    v_mfma_f32_16x16x32_bf16 v[120:123], v[144:147], v[148:151], v[120:123]
    v_mov_b32 v53, 115068
    ds_write_b32 v53, v52
    s_waitcnt lgkmcnt(9)
    v_mfma_f32_16x16x32_bf16 v[120:123], v[152:155], v[156:159], v[120:123]
    ds_write_b32 v53, v52 offset:3072
    s_waitcnt lgkmcnt(8)
    v_mfma_f32_16x16x32_bf16 v[120:123], v[160:163], v[164:167], v[120:123]
    s_waitcnt lgkmcnt(6)
    v_mfma_f32_16x16x32_bf16 v[120:123], v[168:171], v[172:175], v[120:123]
    s_waitcnt lgkmcnt(4)
    v_mfma_f32_16x16x32_bf16 v[120:123], v[176:179], v[180:183], v[120:123]
    s_waitcnt lgkmcnt(2)
    v_mfma_f32_16x16x32_bf16 v[120:123], v[184:187], v[188:191], v[120:123]
    s_cmp_lg_u32 s82, 0
    s_cbranch_scc1 L_tab1
    s_nop 5
    ds_write_b64 v45, v[120:121]
    ds_write_b64 v46, v[122:123]
    s_branch L_tab2
L_tab1:
    s_mov_b64 exec, 0x1ffff
    s_nop 6
    ds_write_b32 v47, v120
    s_mov_b64 exec, 0xffff
    ds_write_b32 v47, v121 offset:128
    ds_write_b32 v47, v122 offset:256
    ds_write_b32 v47, v123 offset:384
    s_mov_b64 exec, -1
L_tab2:
    v_and_b32 v50, 255, v0
    v_lshlrev_b32 v49, 5, v0
    v_add_u32 v49, 86016, v49
    v_lshlrev_b32 v50, 4, v50
    s_cmp_ge_u32 s3, 4
    s_cselect_b32 s81, 33328, 48
    v_add_u32 v50, s81, v50
    v_mov_b32 v56, 0
    v_mov_b32 v57, 0
    v_mov_b32 v58, 0
    v_mov_b32 v59, 0
    v_and_b32 v51, 3, v1
    v_min_u32 v51, 2, v51
    v_lshrrev_b32 v52, 2, v1
    v_mul_u32_u24 v52, 4160, v52
    v_lshl_add_u32 v51, v51, 4, v52
    v_min_u32 v52, 14, v40
    v_mul_u32_u24 v53, 1280, v41
    v_lshl_add_u32 v52, v52, 4, v53
    v_add_u32 v52, 66560, v52
    s_waitcnt lgkmcnt(0)
    s_barrier
    s_mov_b64 exec, 1
    ds_read_b32 v68, v108
    ds_read_b32 v69, v109
    ds_read_b32 v70, v110
    ds_read_b32 v71, v111
    ds_read_b32 v72, v112
    ds_read_b32 v73, v113
    ds_read_b32 v74, v114
    s_mov_b64 exec, -1
    ds_read_b32 v67, v107
    ds_read_b32 v66, v106
    ds_read_b32 v65, v105
    ds_read_b32 v64, v104
    ds_read_b32 v63, v103
    ds_read_b32 v62, v102
    ds_read_b32 v61, v101
    ds_read_b32 v60, v100
    v_lshlrev_b32 v45, 5, v0
    s_mov_b32 s88, 32768
    s_lshl_b32 s89, s66, 14
    s_add_u32 s89, s89, 10092544
    buffer_load_dwordx4 v[136:139], v45, s[52:55], s89 offen sc1
    buffer_load_dwordx4 v[140:143], v45, s[52:55], s89 offen offset:16 sc1
    buffer_load_dwordx4 v[144:147], v45, s[52:55], s88 offen sc1
    buffer_load_dwordx4 v[148:151], v45, s[52:55], s88 offen offset:16 sc1
    s_mov_b32 s83, 0x05040100
    s_mov_b32 s84, 0x07060302
    ds_write_b128 v51, v[56:59] offset:0
    ds_write_b128 v52, v[56:59]
    ds_write_b128 v52, v[56:59] offset:5120
    s_waitcnt lgkmcnt(10)
    v_mov_b32 v124, v67
    s_waitcnt lgkmcnt(9)
    v_add_f32 v125, v124, v66
    s_waitcnt lgkmcnt(8)
    v_add_f32 v126, v125, v65
    s_waitcnt lgkmcnt(7)
    v_add_f32 v127, v126, v64
    s_waitcnt lgkmcnt(6)
    v_add_f32 v128, v127, v63
    s_waitcnt lgkmcnt(5)
    v_add_f32 v129, v128, v62
    s_waitcnt lgkmcnt(4)
    v_add_f32 v130, v129, v61
    s_waitcnt lgkmcnt(3)
    v_add_f32 v131, v130, v60
    v_mov_b32 v122, v131
    v_mov_b32_dpp v68, v60 wave_shr:1 row_mask:0xf bank_mask:0xf
    v_mov_b32_dpp v69, v61 wave_shr:1 row_mask:0xf bank_mask:0xf
    v_mov_b32_dpp v70, v62 wave_shr:1 row_mask:0xf bank_mask:0xf
    v_mov_b32_dpp v71, v63 wave_shr:1 row_mask:0xf bank_mask:0xf
    v_mov_b32_dpp v72, v64 wave_shr:1 row_mask:0xf bank_mask:0xf
    v_mov_b32_dpp v73, v65 wave_shr:1 row_mask:0xf bank_mask:0xf
    v_mov_b32_dpp v74, v66 wave_shr:1 row_mask:0xf bank_mask:0xf
    v_cvt_pk_bf16_f32 v76, v60, v61
    v_cvt_pk_bf16_f32 v77, v62, v63
    v_cvt_pk_bf16_f32 v78, v64, v65
    v_cvt_pk_bf16_f32 v79, v66, v67
    v_cvt_pk_bf16_f32 v80, v68, v69
    v_cvt_pk_bf16_f32 v81, v70, v71
    ds_write_b128 v50, v[76:79] offset:29120
    v_add_f32_dpp v122, v122, v122 row_shr:1 row_mask:0xf bank_mask:0xf
    ds_write_b128 v50, v[78:81] offset:12480
    v_cvt_pk_bf16_f32 v84, v62, v63
    v_cvt_pk_bf16_f32 v85, v64, v65
    v_cvt_pk_bf16_f32 v86, v66, v67
    v_cvt_pk_bf16_f32 v87, v68, v69
    v_cvt_pk_bf16_f32 v88, v70, v71
    v_cvt_pk_bf16_f32 v89, v72, v73
    v_add_f32_dpp v122, v122, v122 row_shr:2 row_mask:0xf bank_mask:0xf
    ds_write_b128 v50, v[84:87] offset:20800
    ds_write_b128 v50, v[86:89] offset:4160
    v_add_f32_dpp v122, v122, v122 row_shr:4 row_mask:0xf bank_mask:0xf
    v_cvt_pk_bf16_f32 v90, v61, v62
    v_cvt_pk_bf16_f32 v91, v63, v64
    v_cvt_pk_bf16_f32 v92, v65, v66
    v_cvt_pk_bf16_f32 v93, v67, v68
    v_cvt_pk_bf16_f32 v94, v69, v70
    v_cvt_pk_bf16_f32 v95, v71, v72
    v_add_f32_dpp v122, v122, v122 row_shr:8 row_mask:0xf bank_mask:0xf
    ds_write_b128 v50, v[90:93] offset:24960
    ds_write_b128 v50, v[92:95] offset:8320
    v_add_f32_dpp v122, v122, v122 row_bcast:15 row_mask:0xa bank_mask:0xf
    v_cvt_pk_bf16_f32 v116, v63, v64
    v_cvt_pk_bf16_f32 v117, v65, v66
    v_cvt_pk_bf16_f32 v118, v67, v68
    v_cvt_pk_bf16_f32 v119, v69, v70
    v_cvt_pk_bf16_f32 v120, v71, v72
    v_cvt_pk_bf16_f32 v121, v73, v74
    v_add_f32_dpp v122, v122, v122 row_bcast:31 row_mask:0xc bank_mask:0xf
    ds_write_b128 v50, v[116:119] offset:16640
    ds_write_b128 v50, v[118:121] offset:0
    v_sub_f32 v123, v122, v131
    s_lshl_b32 s81, s3, 2
    s_add_u32 s81, s81, 118144
    v_mov_b32 v53, s81
    v_pk_add_f32 v[124:125], v[124:125], v[122:123] op_sel:[0,1] op_sel_hi:[1,1]
    v_pk_add_f32 v[126:127], v[126:127], v[122:123] op_sel:[0,1] op_sel_hi:[1,1]
    v_pk_add_f32 v[128:129], v[128:129], v[122:123] op_sel:[0,1] op_sel_hi:[1,1]
    v_pk_add_f32 v[130:131], v[130:131], v[122:123] op_sel:[0,1] op_sel_hi:[1,1]
    ds_write_b128 v49, v[124:127]
    ds_write_b128 v49, v[128:131] offset:16
    s_mov_b32 exec_lo, 0
    s_mov_b32 exec_hi, 0x80000000
    ds_write_b32 v53, v122
    s_mov_b64 exec, -1
    v_lshrrev_b32 v46, 3, v0
    v_bfe_u32 v47, v0, 1, 2
    v_and_b32 v48, 1, v0
    v_lshlrev_b32 v48, 3, v48
    v_lshl_add_u32 v48, v46, 4, v48
    v_mul_u32_u24 v46, 1280, v47
    v_add_u32 v46, v46, v48
    v_add_u32 v46, 66800, v46
    v_lshl_add_u32 v47, v47, 10, v48
    v_add_u32 v47, 76800, v47
    s_lshr_b32 s77, s3, 2
    s_bfe_u32 s78, s3, 0x10001
    s_and_b32 s79, s3, 1
    s_mul_i32 s85, s77, 5120
    s_lshl_b32 s86, s78, 4
    s_sub_u32 s85, s85, s86
    s_add_u32 s85, s85, 66576
    v_mul_u32_u24 v42, 1280, v41
    v_lshl_add_u32 v42, v40, 4, v42
    v_add_u32 v43, s85, v42
    s_mul_i32 s85, s77, 33280
    s_mul_i32 s86, s79, 16640
    s_add_u32 s85, s85, s86
    s_lshl_b32 s86, s78, 6
    s_add_u32 s85, s85, s86
    s_add_u32 s85, s85, 48
    v_and_b32 v44, 3, v40
    v_mul_u32_u24 v44, 4160, v44
    v_lshrrev_b32 v49, 2, v40
    v_sub_u32 v49, v49, v41
    v_lshl_add_u32 v44, v49, 4, v44
    v_add_u32 v44, s85, v44
    v_min_u32 v50, 3, v1
    v_lshrrev_b32 v51, 1, v50
    v_and_b32 v51, v51, v50
    v_add_u32 v50, v50, v51
    v_mul_u32_u24 v50, 1792, v50
    s_lshl_b32 s80, s66, 3
    s_add_u32 s80, s80, 49152
    s_and_b32 s85, s64, 7
    s_lshl_b32 s85, s85, 2
    s_and_b32 s86, s3, 3
    s_add_u32 s85, s85, s86
    s_mul_i32 s85, s85, 50176
    s_lshl_b32 s86, s65, 9
    s_add_u32 s69, s85, s86
    v_lshrrev_b32 v51, 5, v1
    v_mul_u32_u24 v51, 3584, v51
    v_and_b32 v52, 31, v1
    v_lshl_add_u32 v51, v52, 4, v51
    s_cmp_ge_u32 s3, 4
    s_cselect_b32 s56, s38, s36
    s_cselect_b32 s57, s39, s37
    s_mov_b32 s58, 1605632
    s_waitcnt vmcnt(3)
    v_xor_b32 v76, s60, v137
    v_xor_b32 v77, s60, v139
    s_waitcnt vmcnt(2)
    v_xor_b32 v78, s60, v141
    v_or3_b32 v76, v76, v77, v78
    v_xor_b32 v77, s60, v143
    s_waitcnt vmcnt(1)
    v_xor_b32 v78, s60, v145
    v_or3_b32 v76, v76, v77, v78
    v_xor_b32 v77, s60, v147
    s_waitcnt vmcnt(0)
    v_xor_b32 v78, s60, v149
    v_or3_b32 v76, v76, v77, v78
    v_xor_b32 v77, s60, v151
    v_or_b32 v76, v76, v77
    v_cmp_ne_u32 vcc, 0, v76
    s_nop 4
    s_cbranch_vccz L_s1ok
    s_mov_b32 s87, 0
L_poll0:
    buffer_load_dwordx4 v[136:139], v45, s[52:55], s89 offen sc1
    buffer_load_dwordx4 v[140:143], v45, s[52:55], s89 offen offset:16 sc1
    buffer_load_dwordx4 v[144:147], v45, s[52:55], s88 offen sc1
    buffer_load_dwordx4 v[148:151], v45, s[52:55], s88 offen offset:16 sc1
    s_waitcnt vmcnt(0)
    v_xor_b32 v76, s60, v137
    v_xor_b32 v77, s60, v139
    v_xor_b32 v78, s60, v141
    v_or3_b32 v76, v76, v77, v78
    v_xor_b32 v77, s60, v143
    v_xor_b32 v78, s60, v145
    v_or3_b32 v76, v76, v77, v78
    v_xor_b32 v77, s60, v147
    v_xor_b32 v78, s60, v149
    v_or3_b32 v76, v76, v77, v78
    v_xor_b32 v77, s60, v151
    v_or_b32 v76, v76, v77
    v_cmp_ne_u32 vcc, 0, v76
    s_nop 4
    s_cbranch_vccz L_pdone0
    s_sleep 1
    s_add_u32 s87, s87, 1
    s_cmp_lt_u32 s87, 20000
    s_cbranch_scc1 L_poll0
L_pdone0:
L_s1ok:
    v_and_b32 v76, 0xffff0000, v144
    v_lshlrev_b32 v144, 16, v144
    v_rcp_f32 v76, v76
    v_and_b32 v77, 0xffff0000, v146
    v_lshlrev_b32 v146, 16, v146
    v_rcp_f32 v77, v77
    v_and_b32 v78, 0xffff0000, v148
    v_lshlrev_b32 v148, 16, v148
    v_rcp_f32 v78, v78
    v_and_b32 v79, 0xffff0000, v150
    v_lshlrev_b32 v150, 16, v150
    v_rcp_f32 v79, v79
    v_perm_b32 v80, v138, v136, s83
    v_perm_b32 v81, v142, v140, s83
    v_perm_b32 v82, v138, v136, s84
    v_perm_b32 v83, v142, v140, s84
    ds_write_b64 v47, v[80:81]
    ds_write_b64 v47, v[82:83] offset:4096
    v_and_b32 v137, 0xffff0000, v136
    v_lshlrev_b32 v136, 16, v136
    v_and_b32 v139, 0xffff0000, v138
    v_lshlrev_b32 v138, 16, v138
    v_and_b32 v141, 0xffff0000, v140
    v_lshlrev_b32 v140, 16, v140
    v_and_b32 v143, 0xffff0000, v142
    v_lshlrev_b32 v142, 16, v142
    v_pk_add_f32 v[136:137], v[136:137], v[144:145] op_sel_hi:[1,0] neg_lo:[0,1] neg_hi:[0,1]
    v_pk_add_f32 v[138:139], v[138:139], v[146:147] op_sel_hi:[1,0] neg_lo:[0,1] neg_hi:[0,1]
    v_pk_add_f32 v[140:141], v[140:141], v[148:149] op_sel_hi:[1,0] neg_lo:[0,1] neg_hi:[0,1]
    v_pk_add_f32 v[142:143], v[142:143], v[150:151] op_sel_hi:[1,0] neg_lo:[0,1] neg_hi:[0,1]
    v_pk_mul_f32 v[136:137], v[136:137], v[76:77] op_sel:[0,0] op_sel_hi:[1,0]
    v_pk_mul_f32 v[138:139], v[138:139], v[76:77] op_sel:[0,1] op_sel_hi:[1,1]
    v_pk_mul_f32 v[140:141], v[140:141], v[78:79] op_sel:[0,0] op_sel_hi:[1,0]
    v_pk_mul_f32 v[142:143], v[142:143], v[78:79] op_sel:[0,1] op_sel_hi:[1,1]
    v_cvt_pk_bf16_f32 v84, v136, v138
    v_cvt_pk_bf16_f32 v85, v140, v142
    v_cvt_pk_bf16_f32 v86, v137, v139
    v_cvt_pk_bf16_f32 v87, v141, v143
    ds_write_b64 v46, v[84:85]
    ds_write_b64 v46, v[86:87] offset:5120
    s_waitcnt lgkmcnt(0)
    s_barrier
    ds_read_b128 v[128:131], v44 offset:0
    ds_read_b128 v[144:147], v43 offset:224
    ds_read_b128 v[148:151], v43 offset:480
    ds_read_b128 v[152:155], v43 offset:736
    ds_read_b128 v[156:159], v43 offset:992
    ds_read_b128 v[132:135], v44 offset:1024
    ds_read_b128 v[136:139], v44 offset:2048
    ds_read_b128 v[140:143], v44 offset:3072
    s_waitcnt lgkmcnt(6)
    v_mfma_f32_16x16x32_bf16 v[200:203], v[128:131], v[144:147], 0
    ds_read_b128 v[160:163], v44 offset:128
    s_waitcnt lgkmcnt(6)
    v_mfma_f32_16x16x32_bf16 v[204:207], v[128:131], v[148:151], 0
    ds_read_b128 v[176:179], v43 offset:192
    s_waitcnt lgkmcnt(6)
    v_mfma_f32_16x16x32_bf16 v[208:211], v[128:131], v[152:155], 0
    ds_read_b128 v[180:183], v43 offset:448
    s_waitcnt lgkmcnt(6)
    v_mfma_f32_16x16x32_bf16 v[212:215], v[128:131], v[156:159], 0
    ds_read_b128 v[184:187], v43 offset:704
    s_waitcnt lgkmcnt(6)
    v_mfma_f32_16x16x32_bf16 v[204:207], v[132:135], v[144:147], v[204:207]
    ds_read_b128 v[188:191], v43 offset:960
    v_mfma_f32_16x16x32_bf16 v[208:211], v[132:135], v[148:151], v[208:211]
    ds_read_b128 v[164:167], v44 offset:1152
    v_mfma_f32_16x16x32_bf16 v[212:215], v[132:135], v[152:155], v[212:215]
    ds_read_b128 v[168:171], v44 offset:2176
    s_waitcnt lgkmcnt(8)
    v_mfma_f32_16x16x32_bf16 v[208:211], v[136:139], v[144:147], v[208:211]
    ds_read_b128 v[172:175], v44 offset:3200
    v_mfma_f32_16x16x32_bf16 v[212:215], v[136:139], v[148:151], v[212:215]
    s_waitcnt lgkmcnt(8)
    v_mfma_f32_16x16x32_bf16 v[212:215], v[140:143], v[144:147], v[212:215]
    buffer_load_dwordx2 v[54:55], v50, s[52:55], s80 offen sc1
    buffer_load_dwordx4 v[220:223], v51, s[56:59], s69 offen
    s_add_u32 s69, s69, 7168
    buffer_load_dwordx4 v[224:227], v51, s[56:59], s69 offen
    s_add_u32 s69, s69, 7168
    s_waitcnt lgkmcnt(6)
    v_mfma_f32_16x16x32_bf16 v[200:203], v[160:163], v[176:179], v[200:203]
    ds_read_b128 v[128:131], v44 offset:256
    s_waitcnt lgkmcnt(6)
    v_mfma_f32_16x16x32_bf16 v[204:207], v[160:163], v[180:183], v[204:207]
    ds_read_b128 v[144:147], v43 offset:160
    s_waitcnt lgkmcnt(6)
    v_mfma_f32_16x16x32_bf16 v[208:211], v[160:163], v[184:187], v[208:211]
    ds_read_b128 v[148:151], v43 offset:416
    s_waitcnt lgkmcnt(6)
    v_mfma_f32_16x16x32_bf16 v[212:215], v[160:163], v[188:191], v[212:215]
    ds_read_b128 v[152:155], v43 offset:672
    s_waitcnt lgkmcnt(6)
    v_mfma_f32_16x16x32_bf16 v[204:207], v[164:167], v[176:179], v[204:207]
    ds_read_b128 v[156:159], v43 offset:928
    v_mfma_f32_16x16x32_bf16 v[208:211], v[164:167], v[180:183], v[208:211]
    ds_read_b128 v[132:135], v44 offset:1280
    v_mfma_f32_16x16x32_bf16 v[212:215], v[164:167], v[184:187], v[212:215]
    ds_read_b128 v[136:139], v44 offset:2304
    s_waitcnt lgkmcnt(8)
    v_mfma_f32_16x16x32_bf16 v[208:211], v[168:171], v[176:179], v[208:211]
    ds_read_b128 v[140:143], v44 offset:3328
    v_mfma_f32_16x16x32_bf16 v[212:215], v[168:171], v[180:183], v[212:215]
    s_and_b32 s78, s3, 3
    s_lshl_b32 s84, s77, 14
    s_add_u32 s84, s84, 120064
    s_waitcnt lgkmcnt(8)
    v_mfma_f32_16x16x32_bf16 v[212:215], v[172:175], v[176:179], v[212:215]
    s_lshl_b32 s86, s78, 10
    s_add_u32 s86, s86, s84
    buffer_load_dwordx4 v[228:231], v51, s[56:59], s69 offen
    s_add_u32 s69, s69, 7168
    buffer_load_dwordx4 v[232:235], v51, s[56:59], s69 offen
    s_add_u32 s69, s69, 7168
    s_waitcnt lgkmcnt(6)
    v_mfma_f32_16x16x32_bf16 v[200:203], v[128:131], v[144:147], v[200:203]
    ds_read_b128 v[160:163], v44 offset:384
    s_waitcnt lgkmcnt(6)
    v_mfma_f32_16x16x32_bf16 v[204:207], v[128:131], v[148:151], v[204:207]
    ds_read_b128 v[176:179], v43 offset:128
    s_waitcnt lgkmcnt(6)
    v_mfma_f32_16x16x32_bf16 v[208:211], v[128:131], v[152:155], v[208:211]
    ds_read_b128 v[180:183], v43 offset:384
    s_waitcnt lgkmcnt(6)
    v_mfma_f32_16x16x32_bf16 v[212:215], v[128:131], v[156:159], v[212:215]
    ds_read_b128 v[184:187], v43 offset:640
    s_waitcnt lgkmcnt(6)
    v_mfma_f32_16x16x32_bf16 v[204:207], v[132:135], v[144:147], v[204:207]
    ds_read_b128 v[188:191], v43 offset:896
    v_mfma_f32_16x16x32_bf16 v[208:211], v[132:135], v[148:151], v[208:211]
    ds_read_b128 v[164:167], v44 offset:1408
    v_mfma_f32_16x16x32_bf16 v[212:215], v[132:135], v[152:155], v[212:215]
    ds_read_b128 v[168:171], v44 offset:2432
    s_waitcnt lgkmcnt(8)
    v_mfma_f32_16x16x32_bf16 v[208:211], v[136:139], v[144:147], v[208:211]
    ds_read_b128 v[172:175], v44 offset:3456
    v_mfma_f32_16x16x32_bf16 v[212:215], v[136:139], v[148:151], v[212:215]
    v_add_u32 v45, s86, v2
    s_lshl_b32 s86, s78, 12
    s_add_u32 s86, s86, s84
    s_waitcnt lgkmcnt(8)
    v_mfma_f32_16x16x32_bf16 v[212:215], v[140:143], v[144:147], v[212:215]
    v_add_u32 v46, s86, v2
    s_mul_i32 s84, s77, 5120
    s_lshl_b32 s86, s78, 8
    buffer_load_dwordx4 v[236:239], v51, s[56:59], s69 offen
    s_add_u32 s69, s69, 7168
    buffer_load_dwordx4 v[240:243], v51, s[56:59], s69 offen
    s_add_u32 s69, s69, 7168
    s_waitcnt lgkmcnt(6)
    v_mfma_f32_16x16x32_bf16 v[200:203], v[160:163], v[176:179], v[200:203]
    ds_read_b128 v[128:131], v44 offset:512
    s_waitcnt lgkmcnt(6)
    v_mfma_f32_16x16x32_bf16 v[204:207], v[160:163], v[180:183], v[204:207]
    ds_read_b128 v[144:147], v43 offset:96
    s_waitcnt lgkmcnt(6)
    v_mfma_f32_16x16x32_bf16 v[208:211], v[160:163], v[184:187], v[208:211]
    ds_read_b128 v[148:151], v43 offset:352
    s_waitcnt lgkmcnt(6)
    v_mfma_f32_16x16x32_bf16 v[212:215], v[160:163], v[188:191], v[212:215]
    ds_read_b128 v[152:155], v43 offset:608
    s_waitcnt lgkmcnt(6)
    v_mfma_f32_16x16x32_bf16 v[204:207], v[164:167], v[176:179], v[204:207]
    ds_read_b128 v[156:159], v43 offset:864
    v_mfma_f32_16x16x32_bf16 v[208:211], v[164:167], v[180:183], v[208:211]
    ds_read_b128 v[132:135], v44 offset:1536
    v_mfma_f32_16x16x32_bf16 v[212:215], v[164:167], v[184:187], v[212:215]
    ds_read_b128 v[136:139], v44 offset:2560
    s_waitcnt lgkmcnt(8)
    v_mfma_f32_16x16x32_bf16 v[208:211], v[168:171], v[176:179], v[208:211]
    ds_read_b128 v[140:143], v44 offset:3584
    v_mfma_f32_16x16x32_bf16 v[212:215], v[168:171], v[180:183], v[212:215]
    s_add_u32 s84, s84, s86
    s_add_u32 s84, s84, 66800
    s_waitcnt lgkmcnt(8)
    v_mfma_f32_16x16x32_bf16 v[212:215], v[172:175], v[176:179], v[212:215]
    v_add_u32 v47, s84, v42
    s_lshl_b32 s84, s77, 12
    s_add_u32 s84, s84, s86
    buffer_load_dwordx4 v[244:247], v51, s[56:59], s69 offen
    s_add_u32 s69, s69, 7168
    s_waitcnt lgkmcnt(6)
    v_mfma_f32_16x16x32_bf16 v[200:203], v[128:131], v[144:147], v[200:203]
    ds_read_b128 v[160:163], v44 offset:640
    s_waitcnt lgkmcnt(6)
    v_mfma_f32_16x16x32_bf16 v[204:207], v[128:131], v[148:151], v[204:207]
    ds_read_b128 v[176:179], v43 offset:64
    s_waitcnt lgkmcnt(6)
    v_mfma_f32_16x16x32_bf16 v[208:211], v[128:131], v[152:155], v[208:211]
    ds_read_b128 v[180:183], v43 offset:320
    s_waitcnt lgkmcnt(6)
    v_mfma_f32_16x16x32_bf16 v[212:215], v[128:131], v[156:159], v[212:215]
    ds_read_b128 v[184:187], v43 offset:576
    s_waitcnt lgkmcnt(6)
    v_mfma_f32_16x16x32_bf16 v[204:207], v[132:135], v[144:147], v[204:207]
    ds_read_b128 v[188:191], v43 offset:832
    v_mfma_f32_16x16x32_bf16 v[208:211], v[132:135], v[148:151], v[208:211]
    ds_read_b128 v[164:167], v44 offset:1664
    v_mfma_f32_16x16x32_bf16 v[212:215], v[132:135], v[152:155], v[212:215]
    ds_read_b128 v[168:171], v44 offset:2688
    s_waitcnt lgkmcnt(8)
    v_mfma_f32_16x16x32_bf16 v[208:211], v[136:139], v[144:147], v[208:211]
    ds_read_b128 v[172:175], v44 offset:3712
    v_mfma_f32_16x16x32_bf16 v[212:215], v[136:139], v[148:151], v[212:215]
    s_add_u32 s84, s84, 76800
    s_waitcnt lgkmcnt(8)
    v_mfma_f32_16x16x32_bf16 v[212:215], v[140:143], v[144:147], v[212:215]
    v_lshlrev_b32 v48, 4, v40
    s_waitcnt lgkmcnt(6)
    v_mfma_f32_16x16x32_bf16 v[200:203], v[160:163], v[176:179], v[200:203]
    ds_read_b128 v[128:131], v44 offset:768
    s_waitcnt lgkmcnt(6)
    v_mfma_f32_16x16x32_bf16 v[204:207], v[160:163], v[180:183], v[204:207]
    ds_read_b128 v[144:147], v43 offset:32
    s_waitcnt lgkmcnt(6)
    v_mfma_f32_16x16x32_bf16 v[208:211], v[160:163], v[184:187], v[208:211]
    ds_read_b128 v[148:151], v43 offset:288
    s_waitcnt lgkmcnt(6)
    v_mfma_f32_16x16x32_bf16 v[212:215], v[160:163], v[188:191], v[212:215]
    ds_read_b128 v[152:155], v43 offset:544
    s_waitcnt lgkmcnt(6)
    v_mfma_f32_16x16x32_bf16 v[204:207], v[164:167], v[176:179], v[204:207]
    ds_read_b128 v[156:159], v43 offset:800
    v_mfma_f32_16x16x32_bf16 v[208:211], v[164:167], v[180:183], v[208:211]
    ds_read_b128 v[132:135], v44 offset:1792
    v_mfma_f32_16x16x32_bf16 v[212:215], v[164:167], v[184:187], v[212:215]
    ds_read_b128 v[136:139], v44 offset:2816
    s_waitcnt lgkmcnt(8)
    v_mfma_f32_16x16x32_bf16 v[208:211], v[168:171], v[176:179], v[208:211]
    ds_read_b128 v[140:143], v44 offset:3840
    v_mfma_f32_16x16x32_bf16 v[212:215], v[168:171], v[180:183], v[212:215]
    v_lshl_add_u32 v48, v41, 10, v48
    s_waitcnt lgkmcnt(8)
    v_mfma_f32_16x16x32_bf16 v[212:215], v[172:175], v[176:179], v[212:215]
    v_add_u32 v48, s84, v48
    s_lshl_b32 s84, s3, 11
    s_add_u32 s84, s84, 86016
    s_waitcnt lgkmcnt(6)
    v_mfma_f32_16x16x32_bf16 v[200:203], v[128:131], v[144:147], v[200:203]
    ds_read_b128 v[160:163], v44 offset:896
    s_waitcnt lgkmcnt(6)
    v_mfma_f32_16x16x32_bf16 v[204:207], v[128:131], v[148:151], v[204:207]
    ds_read_b128 v[176:179], v43 offset:0
    s_waitcnt lgkmcnt(6)
    v_mfma_f32_16x16x32_bf16 v[208:211], v[128:131], v[152:155], v[208:211]
    ds_read_b128 v[180:183], v43 offset:256
    s_waitcnt lgkmcnt(6)
    v_mfma_f32_16x16x32_bf16 v[212:215], v[128:131], v[156:159], v[212:215]
    ds_read_b128 v[184:187], v43 offset:512
    s_waitcnt lgkmcnt(6)
    v_mfma_f32_16x16x32_bf16 v[204:207], v[132:135], v[144:147], v[204:207]
    ds_read_b128 v[188:191], v43 offset:768
    v_mfma_f32_16x16x32_bf16 v[208:211], v[132:135], v[148:151], v[208:211]
    ds_read_b128 v[164:167], v44 offset:1920
    v_mfma_f32_16x16x32_bf16 v[212:215], v[132:135], v[152:155], v[212:215]
    ds_read_b128 v[168:171], v44 offset:2944
    s_waitcnt lgkmcnt(8)
    v_mfma_f32_16x16x32_bf16 v[208:211], v[136:139], v[144:147], v[208:211]
    ds_read_b128 v[172:175], v44 offset:3968
    v_mfma_f32_16x16x32_bf16 v[212:215], v[136:139], v[148:151], v[212:215]
    v_lshlrev_b32 v49, 7, v40
    s_waitcnt lgkmcnt(8)
    v_mfma_f32_16x16x32_bf16 v[212:215], v[140:143], v[144:147], v[212:215]
    v_lshl_add_u32 v49, v41, 5, v49
    s_waitcnt lgkmcnt(6)
    v_mfma_f32_16x16x32_bf16 v[200:203], v[160:163], v[176:179], v[200:203]
    v_add_u32 v49, s84, v49
    s_lshl_b32 s84, s77, 4
    s_add_u32 s84, s84, 118144
    s_waitcnt lgkmcnt(5)
    v_mfma_f32_16x16x32_bf16 v[204:207], v[160:163], v[180:183], v[204:207]
    v_mov_b32 v52, s84
    s_add_u32 s84, s63, s77
    s_lshl_b32 s84, s84, 12
    s_waitcnt lgkmcnt(4)
    v_mfma_f32_16x16x32_bf16 v[208:211], v[160:163], v[184:187], v[208:211]
    s_lshl_b32 s86, s78, 10
    s_add_u32 s84, s84, s86
    s_add_u32 s85, s84, 2883584
    s_waitcnt lgkmcnt(3)
    v_mfma_f32_16x16x32_bf16 v[212:215], v[160:163], v[188:191], v[212:215]
    s_add_u32 s84, s84, 1048576
    s_waitcnt lgkmcnt(2)
    v_mfma_f32_16x16x32_bf16 v[204:207], v[164:167], v[176:179], v[204:207]
    v_lshlrev_b32 v53, 6, v40
    v_mfma_f32_16x16x32_bf16 v[208:211], v[164:167], v[180:183], v[208:211]
    v_lshl_add_u32 v53, v41, 4, v53
    s_cmp_gt_u32 s78, 0
    s_cselect_b32 s81, 1.0, 0
    v_mfma_f32_16x16x32_bf16 v[212:215], v[164:167], v[184:187], v[212:215]
    s_cmp_gt_u32 s78, 1
    s_cselect_b32 s82, 1.0, 0
    s_cmp_gt_u32 s78, 2
    s_waitcnt lgkmcnt(1)
    v_mfma_f32_16x16x32_bf16 v[208:211], v[168:171], v[176:179], v[208:211]
    s_cselect_b32 s83, 1.0, 0
    v_mfma_f32_16x16x32_bf16 v[212:215], v[168:171], v[180:183], v[212:215]
    s_waitcnt lgkmcnt(0)
    v_mfma_f32_16x16x32_bf16 v[212:215], v[172:175], v[176:179], v[212:215]
    ds_read_b128 v[60:63], v47
    ds_read_b128 v[64:67], v48
    ds_read_b128 v[100:103], v49
    ds_read_b128 v[104:107], v49 offset:16
    ds_read_b128 v[108:111], v52
    ds_write_b128 v45, v[200:203] offset:0
    ds_write_b128 v45, v[204:207] offset:4096
    ds_write_b128 v45, v[208:211] offset:8192
    ds_write_b128 v45, v[212:215] offset:12288
    s_waitcnt vmcnt(7)
    v_cmp_ne_u32 vcc, s60, v55
    s_nop 4
    s_cbranch_vccz L_modok
    s_mov_b32 s87, 0
L_poll1:
    buffer_load_dwordx2 v[54:55], v50, s[52:55], s80 offen sc1
    s_waitcnt vmcnt(0)
    v_cmp_ne_u32 vcc, s60, v55
    s_nop 4
    s_cbranch_vccz L_pdone1
    s_sleep 1
    s_add_u32 s87, s87, 1
    s_cmp_lt_u32 s87, 20000
    s_cbranch_scc1 L_poll1
L_pdone1:
L_modok:
    v_lshlrev_b32 v58, 16, v54
    v_and_b32 v59, 0xffff0000, v54
    s_cmp_ge_u32 s3, 4
    s_cselect_b64 vcc, -1, 0
    v_cndmask_b32 v58, v58, v59, vcc
    s_nop 0
    v_readlane_b32 s86, v58, 0
    v_readlane_b32 s88, v58, 1
    v_readlane_b32 s89, v58, 2
    v_readlane_b32 s79, v58, 3
    s_waitcnt lgkmcnt(8)
    v_lshlrev_b32 v84, 16, v60
    v_and_b32 v85, 0xffff0000, v60
    s_waitcnt lgkmcnt(7)
    v_lshlrev_b32 v92, 16, v64
    v_and_b32 v93, 0xffff0000, v64
    v_lshlrev_b32 v86, 16, v61
    v_and_b32 v87, 0xffff0000, v61
    v_lshlrev_b32 v94, 16, v65
    v_and_b32 v95, 0xffff0000, v65
    v_lshlrev_b32 v88, 16, v62
    v_and_b32 v89, 0xffff0000, v62
    v_lshlrev_b32 v96, 16, v66
    v_and_b32 v97, 0xffff0000, v66
    v_lshlrev_b32 v90, 16, v63
    v_and_b32 v91, 0xffff0000, v63
    v_lshlrev_b32 v98, 16, v67
    v_and_b32 v99, 0xffff0000, v67
    v_mov_b32 v112, s89
    v_mul_f32 v118, s86, v112
    v_mul_f32 v112, s88, v112
    v_mov_b32 v120, s68
    v_mul_f32 v114, v112, v120
    s_waitcnt lgkmcnt(4)
    v_fmac_f32 v120, s81, v108
    v_fmac_f32 v120, s82, v109
    v_fmac_f32 v120, s83, v110
    v_mul_f32 v120, v118, v120
    v_mov_b32 v116, s79
    v_pk_fma_f32 v[92:93], v[84:85], v[114:115], v[92:93] op_sel_hi:[1,0,1]
    v_pk_fma_f32 v[94:95], v[86:87], v[114:115], v[94:95] op_sel_hi:[1,0,1]
    v_pk_fma_f32 v[96:97], v[88:89], v[114:115], v[96:97] op_sel_hi:[1,0,1]
    v_pk_fma_f32 v[98:99], v[90:91], v[114:115], v[98:99] op_sel_hi:[1,0,1]
    v_pk_fma_f32 v[92:93], v[100:101], v[118:119], v[92:93] op_sel_hi:[1,0,1]
    v_pk_fma_f32 v[94:95], v[102:103], v[118:119], v[94:95] op_sel_hi:[1,0,1]
    v_pk_fma_f32 v[96:97], v[104:105], v[118:119], v[96:97] op_sel_hi:[1,0,1]
    v_pk_fma_f32 v[98:99], v[106:107], v[118:119], v[98:99] op_sel_hi:[1,0,1]
    v_pk_add_f32 v[92:93], v[92:93], v[120:121] op_sel_hi:[1,0]
    v_pk_add_f32 v[94:95], v[94:95], v[120:121] op_sel_hi:[1,0]
    v_pk_add_f32 v[96:97], v[96:97], v[120:121] op_sel_hi:[1,0]
    v_pk_add_f32 v[98:99], v[98:99], v[120:121] op_sel_hi:[1,0]
    s_waitcnt lgkmcnt(0)
    s_barrier
    ds_read_b128 v[68:71], v46 offset:0
    ds_read_b128 v[72:75], v46 offset:1024
    ds_read_b128 v[76:79], v46 offset:2048
    ds_read_b128 v[80:83], v46 offset:3072
    s_waitcnt lgkmcnt(3)
    v_pk_fma_f32 v[92:93], v[68:69], v[112:113], v[92:93] op_sel_hi:[1,0,1]
    v_pk_fma_f32 v[94:95], v[70:71], v[112:113], v[94:95] op_sel_hi:[1,0,1]
    s_waitcnt lgkmcnt(2)
    v_pk_fma_f32 v[96:97], v[72:73], v[112:113], v[96:97] op_sel_hi:[1,0,1]
    v_pk_fma_f32 v[98:99], v[74:75], v[112:113], v[98:99] op_sel_hi:[1,0,1]
    s_waitcnt lgkmcnt(1)
    v_pk_fma_f32 v[92:93], v[76:77], v[112:113], v[92:93] op_sel_hi:[1,0,1]
    v_pk_fma_f32 v[94:95], v[78:79], v[112:113], v[94:95] op_sel_hi:[1,0,1]
    s_waitcnt lgkmcnt(0)
    v_pk_fma_f32 v[96:97], v[80:81], v[112:113], v[96:97] op_sel_hi:[1,0,1]
    v_pk_fma_f32 v[98:99], v[82:83], v[112:113], v[98:99] op_sel_hi:[1,0,1]
    v_pk_mul_f32 v[84:85], v[92:93], v[116:117] op_sel_hi:[1,0]
    v_pk_mul_f32 v[86:87], v[94:95], v[116:117] op_sel_hi:[1,0]
    v_pk_mul_f32 v[88:89], v[96:97], v[116:117] op_sel_hi:[1,0]
    v_pk_mul_f32 v[90:91], v[98:99], v[116:117] op_sel_hi:[1,0]
    v_cvt_pk_bf16_f32 v64, v84, v85
    v_cvt_pk_bf16_f32 v65, v86, v87
    v_cvt_pk_bf16_f32 v66, v88, v89
    v_cvt_pk_bf16_f32 v67, v90, v91
    buffer_store_dwordx4 v[64:67], v53, s[52:55], s85 offen sc1
    v_cvt_pk_bf16_f32 v60, v92, v93
    v_cvt_pk_bf16_f32 v61, v94, v95
    v_cvt_pk_bf16_f32 v62, v96, v97
    v_cvt_pk_bf16_f32 v63, v98, v99
    buffer_store_dwordx4 v[60:63], v53, s[52:55], s84 offen sc1
    s_lshl_b32 s72, s65, 9
    s_lshl_b32 s81, s3, 6
    s_add_u32 s72, s72, s81
    v_lshrrev_b32 v24, 2, v1
    v_mul_u32_u24 v24, 3584, v24
    v_and_b32 v25, 3, v1
    v_lshl_add_u32 v24, v25, 4, v24
    v_lshrrev_b32 v25, 5, v1
    v_bfe_u32 v26, v1, 2, 2
    v_lshl_add_u32 v25, v25, 3, v26
    v_lshlrev_b32 v25, 6, v25
    v_bfe_u32 v26, v1, 4, 1
    v_lshl_add_u32 v25, v26, 5, v25
    v_and_b32 v26, 3, v1
    v_lshl_add_u32 v25, v26, 3, v25
    s_lshl_b32 s61, s3, 10
    s_lshl_b32 s62, s3, 13
    s_add_u32 s62, s62, 57344
    s_lshl_b32 s67, s3, 12
    s_add_u32 s67, s67, 122880
    v_add_u32 v26, s62, v25
    v_add_u32 v27, s67, v25
    v_add_u32 v25, s61, v25
    s_lshl_b32 s81, s65, 2
    s_add_u32 s81, s81, 4
    s_add_u32 s81, s81, s3
    s_sub_u32 s82, s81, 28
    s_cmp_ge_u32 s81, 28
    s_cselect_b32 s81, s82, s81
    s_sub_u32 s82, s81, 28
    s_cmp_ge_u32 s81, 28
    s_cselect_b32 s81, s82, s81
    s_mul_i32 s82, s65, 28
    s_add_u32 s82, s82, s81
    s_lshl_b32 s82, s82, 13
    s_add_u32 s73, s82, 8388608
    s_mul_i32 s82, s64, 7
    s_lshr_b32 s83, s81, 2
    s_add_u32 s82, s82, s83
    s_mul_i32 s82, s82, 7
    s_add_u32 s82, s82, s65
    s_lshl_b32 s82, s82, 2
    s_and_b32 s83, s81, 3
    s_add_u32 s82, s82, s83
    s_lshl_b32 s82, s82, 11
    s_add_u32 s77, s82, 13893632
    s_waitcnt vmcnt(0)
    s_barrier
    s_cmp_lg_u32 s3, 0
    s_cbranch_scc1 L_s2a
    v_mov_b32 v40, 1
    s_and_b32 s81, s66, 15
    s_lshl_b32 s81, s81, 8
    s_add_u32 s81, s81, 4096
    v_mov_b32 v41, 0
    s_mov_b64 exec, 1
    buffer_atomic_add v40, v41, s[52:55], s81 offen sc1
    s_mov_b64 exec, -1
L_s2a:
    s_add_u32 m0, s62, 0
    s_nop 0
    buffer_load_dwordx4 v24, s[4:7], s72 offen lds
    s_add_u32 m0, s62, 1024
    s_nop 0
    buffer_load_dwordx4 v24, s[8:11], s72 offen lds
    s_add_u32 s72, s72, 57344
    s_add_u32 m0, s62, 2048
    s_nop 0
    buffer_load_dwordx4 v24, s[4:7], s72 offen lds
    s_add_u32 m0, s62, 3072
    s_nop 0
    buffer_load_dwordx4 v24, s[8:11], s72 offen lds
    s_add_u32 s72, s72, 57344
    s_add_u32 m0, s62, 4096
    s_nop 0
    buffer_load_dwordx4 v24, s[4:7], s72 offen lds
    s_add_u32 m0, s62, 5120
    s_nop 0
    buffer_load_dwordx4 v24, s[8:11], s72 offen lds
    s_add_u32 s72, s72, 57344
    s_add_u32 m0, s62, 6144
    s_nop 0
    buffer_load_dwordx4 v24, s[4:7], s72 offen lds
    s_add_u32 m0, s62, 7168
    s_nop 0
    buffer_load_dwordx4 v24, s[8:11], s72 offen lds
    s_add_u32 s72, s72, 57344
    s_add_u32 m0, s67, 0
    s_nop 0
    buffer_load_dwordx4 v24, s[4:7], s72 offen lds
    s_add_u32 m0, s67, 1024
    s_nop 0
    buffer_load_dwordx4 v24, s[8:11], s72 offen lds
    s_add_u32 s72, s72, 57344
    s_add_u32 m0, s67, 2048
    s_nop 0
    buffer_load_dwordx4 v24, s[4:7], s72 offen lds
    s_add_u32 m0, s67, 3072
    s_nop 0
    buffer_load_dwordx4 v24, s[8:11], s72 offen lds
    s_add_u32 s72, s72, 57344
    s_add_u32 m0, s61, 0
    s_nop 0
    buffer_load_dwordx4 v24, s[4:7], s72 offen lds
    s_add_u32 m0, s61, 8192
    s_nop 0
    buffer_load_dwordx4 v24, s[8:11], s72 offen lds
    s_add_u32 s72, s72, 57344
    s_add_u32 m0, s61, 16384
    s_nop 0
    buffer_load_dwordx4 v24, s[4:7], s72 offen lds
    s_add_u32 m0, s61, 24576
    s_nop 0
    buffer_load_dwordx4 v24, s[8:11], s72 offen lds
    s_add_u32 s72, s72, 57344
    s_add_u32 m0, s61, 32768
    s_nop 0
    buffer_load_dwordx4 v24, s[4:7], s72 offen lds
    s_add_u32 m0, s61, 40960
    s_nop 0
    buffer_load_dwordx4 v24, s[8:11], s72 offen lds
    s_add_u32 s72, s72, 57344
    s_add_u32 m0, s61, 49152
    s_nop 0
    buffer_load_dwordx4 v24, s[4:7], s72 offen lds
    s_waitcnt vmcnt(18)
    ds_read_b64_tr_b16 v[112:113], v26 offset:0
    ds_read_b64_tr_b16 v[114:115], v26 offset:256
    s_waitcnt vmcnt(17)
    ds_read_b64_tr_b16 v[116:117], v26 offset:1024
    ds_read_b64_tr_b16 v[118:119], v26 offset:1280
    s_waitcnt vmcnt(16)
    ds_read_b64_tr_b16 v[120:121], v26 offset:2048
    ds_read_b64_tr_b16 v[122:123], v26 offset:2304
    s_waitcnt lgkmcnt(4)
    s_add_u32 m0, s62, 0
    s_nop 0
    buffer_load_dwordx4 v24, s[8:11], s72 offen lds
    s_add_u32 s72, s72, 57344
    s_waitcnt vmcnt(16)
    ds_read_b64_tr_b16 v[124:125], v26 offset:3072
    ds_read_b64_tr_b16 v[126:127], v26 offset:3328
    s_waitcnt lgkmcnt(4)
    s_add_u32 m0, s62, 1024
    s_nop 0
    buffer_load_dwordx4 v24, s[4:7], s72 offen lds
    s_waitcnt vmcnt(16)
    ds_read_b64_tr_b16 v[128:129], v26 offset:4096
    ds_read_b64_tr_b16 v[130:131], v26 offset:4352
    s_waitcnt lgkmcnt(4)
    s_add_u32 m0, s62, 2048
    s_nop 0
    buffer_load_dwordx4 v24, s[8:11], s72 offen lds
    s_add_u32 s72, s72, 57344
    s_waitcnt vmcnt(16)
    ds_read_b64_tr_b16 v[132:133], v26 offset:5120
    ds_read_b64_tr_b16 v[134:135], v26 offset:5376
    s_waitcnt lgkmcnt(4)
    s_add_u32 m0, s62, 3072
    s_nop 0
    buffer_load_dwordx4 v24, s[4:7], s72 offen lds
    s_waitcnt vmcnt(16)
    ds_read_b64_tr_b16 v[136:137], v26 offset:6144
    ds_read_b64_tr_b16 v[138:139], v26 offset:6400
    s_waitcnt lgkmcnt(4)
    s_add_u32 m0, s62, 4096
    s_nop 0
    buffer_load_dwordx4 v24, s[8:11], s72 offen lds
    s_add_u32 s72, s72, 57344
    s_waitcnt vmcnt(16)
    ds_read_b64_tr_b16 v[140:141], v26 offset:7168
    ds_read_b64_tr_b16 v[142:143], v26 offset:7424
    s_waitcnt lgkmcnt(4)
    s_add_u32 m0, s62, 5120
    s_nop 0
    buffer_load_dwordx4 v24, s[4:7], s72 offen lds
    s_waitcnt vmcnt(16)
    ds_read_b64_tr_b16 v[144:145], v27 offset:0
    ds_read_b64_tr_b16 v[146:147], v27 offset:256
    s_waitcnt lgkmcnt(4)
    s_add_u32 m0, s62, 6144
    s_nop 0
    buffer_load_dwordx4 v24, s[8:11], s72 offen lds
    s_add_u32 s72, s72, 57344
    s_waitcnt vmcnt(16)
    ds_read_b64_tr_b16 v[148:149], v27 offset:1024
    ds_read_b64_tr_b16 v[150:151], v27 offset:1280
    s_waitcnt lgkmcnt(4)
    s_add_u32 m0, s62, 7168
    s_nop 0
    buffer_load_dwordx4 v24, s[4:7], s72 offen lds
    s_waitcnt vmcnt(16)
    ds_read_b64_tr_b16 v[152:153], v27 offset:2048
    ds_read_b64_tr_b16 v[154:155], v27 offset:2304
    s_waitcnt lgkmcnt(4)
    s_add_u32 m0, s67, 0
    s_nop 0
    buffer_load_dwordx4 v24, s[8:11], s72 offen lds
    s_add_u32 s72, s72, 57344
    s_waitcnt vmcnt(16)
    ds_read_b64_tr_b16 v[156:157], v27 offset:3072
    ds_read_b64_tr_b16 v[158:159], v27 offset:3328
    s_waitcnt lgkmcnt(4)
    s_add_u32 m0, s67, 1024
    s_nop 0
    buffer_load_dwordx4 v24, s[4:7], s72 offen lds
    s_waitcnt vmcnt(16)
    ds_read_b64_tr_b16 v[160:161], v25 offset:0
    ds_read_b64_tr_b16 v[162:163], v25 offset:256
    s_waitcnt vmcnt(15)
    ds_read_b64_tr_b16 v[164:165], v25 offset:8192
    ds_read_b64_tr_b16 v[166:167], v25 offset:8448
    s_waitcnt vmcnt(14)
    ds_read_b64_tr_b16 v[168:169], v25 offset:16384
    ds_read_b64_tr_b16 v[170:171], v25 offset:16640
    s_waitcnt vmcnt(13)
    ds_read_b64_tr_b16 v[172:173], v25 offset:24576
    ds_read_b64_tr_b16 v[174:175], v25 offset:24832
    s_waitcnt vmcnt(12)
    ds_read_b64_tr_b16 v[176:177], v25 offset:32768
    ds_read_b64_tr_b16 v[178:179], v25 offset:33024
    s_waitcnt vmcnt(11)
    ds_read_b64_tr_b16 v[180:181], v25 offset:40960
    ds_read_b64_tr_b16 v[182:183], v25 offset:41216
    s_waitcnt vmcnt(10)
    ds_read_b64_tr_b16 v[184:185], v25 offset:49152
    ds_read_b64_tr_b16 v[186:187], v25 offset:49408
    s_waitcnt lgkmcnt(15)
    s_add_u32 m0, s67, 2048
    s_nop 0
    buffer_load_dwordx4 v24, s[8:11], s72 offen lds
    s_add_u32 s72, s72, 57344
    s_waitcnt lgkmcnt(14)
    s_add_u32 m0, s67, 3072
    s_nop 0
    buffer_load_dwordx4 v24, s[4:7], s72 offen lds
    s_lshl_b32 s81, s65, 2
    s_add_u32 s81, s81, 12
    s_add_u32 s81, s81, s3
    s_sub_u32 s82, s81, 28
    s_cmp_ge_u32 s81, 28
    s_cselect_b32 s81, s82, s81
    s_sub_u32 s82, s81, 28
    s_cmp_ge_u32 s81, 28
    s_cselect_b32 s81, s82, s81
    s_mul_i32 s82, s65, 28
    s_add_u32 s82, s82, s81
    s_lshl_b32 s82, s82, 13
    s_add_u32 s74, s82, 8388608
    s_mul_i32 s82, s64, 7
    s_lshr_b32 s83, s81, 2
    s_add_u32 s82, s82, s83
    s_mul_i32 s82, s82, 7
    s_add_u32 s82, s82, s65
    s_lshl_b32 s82, s82, 2
    s_and_b32 s83, s81, 3
    s_add_u32 s82, s82, s83
    s_lshl_b32 s82, s82, 11
    s_add_u32 s78, s82, 13893632
    s_lshl_b32 s81, s65, 2
    s_add_u32 s81, s81, 20
    s_add_u32 s81, s81, s3
    s_sub_u32 s82, s81, 28
    s_cmp_ge_u32 s81, 28
    s_cselect_b32 s81, s82, s81
    s_sub_u32 s82, s81, 28
    s_cmp_ge_u32 s81, 28
    s_cselect_b32 s81, s82, s81
    s_mul_i32 s82, s65, 28
    s_add_u32 s82, s82, s81
    s_lshl_b32 s82, s82, 13
    s_add_u32 s75, s82, 8388608
    s_mul_i32 s82, s64, 7
    s_lshr_b32 s83, s81, 2
    s_add_u32 s82, s82, s83
    s_mul_i32 s82, s82, 7
    s_add_u32 s82, s82, s65
    s_lshl_b32 s82, s82, 2
    s_and_b32 s83, s81, 3
    s_add_u32 s82, s82, s83
    s_lshl_b32 s82, s82, 11
    s_add_u32 s79, s82, 13893632
    s_lshl_b32 s81, s65, 2
    s_add_u32 s81, s81, 28
    s_add_u32 s81, s81, s3
    s_sub_u32 s82, s81, 28
    s_cmp_ge_u32 s81, 28
    s_cselect_b32 s81, s82, s81
    s_sub_u32 s82, s81, 28
    s_cmp_ge_u32 s81, 28
    s_cselect_b32 s81, s82, s81
    s_mul_i32 s82, s65, 28
    s_add_u32 s82, s82, s81
    s_lshl_b32 s82, s82, 13
    s_add_u32 s76, s82, 8388608
    s_cmp_ge_u32 s3, 4
    s_cselect_b32 s81, s54, 0
    v_add_u32 v3, s81, v2
    v_lshrrev_b32 v4, 3, v1
    v_and_b32 v5, 7, v1
    v_and_b32 v6, 2, v4
    s_and_b32 s81, s3, 1
    v_or_b32 v6, s81, v6
    v_lshlrev_b32 v6, 1, v6
    v_xor_b32 v5, v5, v6
    v_lshlrev_b32 v5, 4, v5
    v_lshl_add_u32 v4, v4, 12, v5
    v_bfe_u32 v6, v1, 2, 2
    v_lshrrev_b32 v7, 5, v1
    v_lshl_add_u32 v5, v7, 3, v6
    v_lshlrev_b32 v5, 7, v5
    v_and_b32 v6, 2, v6
    v_or_b32 v6, v6, v7
    v_bfe_u32 v7, v1, 4, 1
    v_xor_b32 v6, v6, v7
    v_lshl_add_u32 v5, v6, 5, v5
    v_and_b32 v6, 3, v1
    v_lshl_add_u32 v5, v6, 3, v5
    v_xor_b32 v6, 64, v5
    v_lshlrev_b32 v9, 3, v1
    s_lshl_b32 s84, s3, 15
    s_lshl_b32 s82, s64, 7
    s_add_u32 s84, s84, s82
    s_lshl_b32 s85, s65, 18
    s_add_u32 s85, s85, s84
    s_add_u32 s85, s85, 1048576
    s_add_u32 s84, s84, 2883584
    s_lshl_b32 s86, s3, 10
    s_lshl_b32 s88, s64, 9
    s_add_u32 s88, s88, 65536
    s_cmp_lg_u32 s3, 0
    s_cbranch_scc1 L_s2b
    v_lshlrev_b32 v13, 8, v1
    s_mov_b32 s81, 4096
    s_mov_b64 exec, 0xffff
    s_mov_b32 s87, 0
L_poll2:
    buffer_load_dword v14, v13, s[52:55], s81 offen sc1
    s_waitcnt vmcnt(0)
    v_cmp_ne_u32 vcc, 14, v14
    s_nop 4
    s_cbranch_vccz L_pdone2
    s_sleep 1
    s_add_u32 s87, s87, 1
    s_cmp_lt_u32 s87, 20000
    s_cbranch_scc1 L_poll2
L_pdone2:
    s_mov_b64 exec, -1
    s_cmp_lg_u32 s2, 0
    s_cbranch_scc1 L_s2b
    v_mov_b32 v14, s60
    v_mov_b32 v13, 0
    s_mov_b64 exec, 1
    buffer_store_dword v14, v13, s[52:55], 0 offen sc1
    s_mov_b64 exec, -1
L_s2b:
    s_waitcnt lgkmcnt(0)
    s_barrier
    s_add_u32 m0, s86, 0
    s_nop 0
    buffer_load_dwordx4 v4, s[52:55], s84 offen sc1 lds
    s_add_u32 s84, s84, 262144
    s_add_u32 m0, s86, 8192
    s_nop 0
    buffer_load_dwordx4 v4, s[52:55], s84 offen sc1 lds
    s_add_u32 s84, s84, 262144
    s_add_u32 m0, s86, 16384
    s_nop 0
    buffer_load_dwordx4 v4, s[52:55], s84 offen sc1 lds
    s_add_u32 s84, s84, 262144
    s_add_u32 m0, s86, 24576
    s_nop 0
    buffer_load_dwordx4 v4, s[52:55], s84 offen sc1 lds
    s_add_u32 s84, s84, 262144
    s_add_u32 m0, s86, 32768
    s_nop 0
    buffer_load_dwordx4 v4, s[52:55], s84 offen sc1 lds
    s_add_u32 s84, s84, 262144
    s_add_u32 m0, s86, 40960
    s_nop 0
    buffer_load_dwordx4 v4, s[52:55], s84 offen sc1 lds
    s_add_u32 s84, s84, 262144
    s_add_u32 m0, s86, 49152
    s_nop 0
    buffer_load_dwordx4 v4, s[52:55], s84 offen sc1 lds
    s_add_u32 m0, s86, 155648
    s_nop 0
    buffer_load_dwordx4 v4, s[52:55], s85 offen sc1 lds
    s_waitcnt vmcnt(0)
    s_barrier
    v_min_u32 v8, 27, v1
    v_and_b32 v7, 0x18, v8
    v_lshlrev_b32 v7, 4, v7
    v_and_b32 v8, 7, v8
    v_lshl_add_u32 v7, v8, 2, v7
    v_add_u32 v7, 512, v7
    s_lshl_b32 s86, s65, 3
    s_add_u32 s86, s86, s3
    s_lshl_b32 s86, s86, 11
    s_add_u32 s86, s86, 4718592
    ds_read_b64_tr_b16 v[96:97], v5 offset:0
    ds_read_b64_tr_b16 v[98:99], v5 offset:512
    ds_read_b64_tr_b16 v[100:101], v6 offset:0
    ds_read_b64_tr_b16 v[102:103], v6 offset:512
    s_waitcnt lgkmcnt(2)
    v_mfma_f32_32x32x16_bf16 v[32:47], v[112:115], v[96:99], 0
    ds_read_b64_tr_b16 v[104:105], v5 offset:2048
    ds_read_b64_tr_b16 v[188:189], v26 offset:0
    s_waitcnt lgkmcnt(2)
    v_mfma_f32_32x32x16_bf16 v[48:63], v[112:115], v[100:103], 0
    ds_read_b64_tr_b16 v[106:107], v5 offset:2560
    ds_read_b64_tr_b16 v[190:191], v26 offset:256
    v_mfma_f32_32x32x16_bf16 v[64:79], v[116:119], v[96:99], 0
    ds_read_b64_tr_b16 v[108:109], v6 offset:2048
    ds_read_b64_tr_b16 v[192:193], v26 offset:1024
    v_mfma_f32_32x32x16_bf16 v[80:95], v[116:119], v[100:103], 0
    ds_read_b64_tr_b16 v[110:111], v6 offset:2560
    ds_read_b64_tr_b16 v[194:195], v26 offset:1280
    s_waitcnt lgkmcnt(5)
    v_mfma_f32_32x32x16_bf16 v[32:47], v[120:123], v[104:107], v[32:47]
    ds_read_b64_tr_b16 v[96:97], v5 offset:4096
    ds_read_b64_tr_b16 v[196:197], v26 offset:2048
    v_mov_b32 v17, 0
    s_waitcnt lgkmcnt(3)
    v_mfma_f32_32x32x16_bf16 v[48:63], v[120:123], v[108:111], v[48:63]
    ds_read_b64_tr_b16 v[98:99], v5 offset:4608
    ds_read_b64_tr_b16 v[198:199], v26 offset:2304
    v_mov_b32 v19, 0
    s_add_u32 m0, s62, 0
    s_nop 0
    buffer_load_dwordx4 v24, s[8:11], s72 offen lds
    s_add_u32 s72, s72, 57344
    v_mfma_f32_32x32x16_bf16 v[64:79], v[124:127], v[104:107], v[64:79]
    ds_read_b64_tr_b16 v[100:101], v6 offset:4096
    ds_read_b64_tr_b16 v[200:201], v26 offset:3072
    v_mov_b32 v21, 0
    v_mfma_f32_32x32x16_bf16 v[80:95], v[124:127], v[108:111], v[80:95]
    ds_read_b64_tr_b16 v[102:103], v6 offset:4608
    ds_read_b64_tr_b16 v[202:203], v26 offset:3328
    v_mov_b32 v23, 0
    s_waitcnt lgkmcnt(8)
    s_add_u32 m0, s62, 1024
    s_nop 0
    buffer_load_dwordx4 v24, s[4:7], s72 offen lds
    s_waitcnt lgkmcnt(5)
    v_mfma_f32_32x32x16_bf16 v[32:47], v[128:131], v[96:99], v[32:47]
    ds_read_b64_tr_b16 v[104:105], v5 offset:6144
    ds_read_b64_tr_b16 v[204:205], v26 offset:4096
    s_waitcnt lgkmcnt(3)
    v_mfma_f32_32x32x16_bf16 v[48:63], v[128:131], v[100:103], v[48:63]
    ds_read_b64_tr_b16 v[106:107], v5 offset:6656
    ds_read_b64_tr_b16 v[206:207], v26 offset:4352
    s_add_u32 m0, s62, 2048
    s_nop 0
    buffer_load_dwordx4 v24, s[8:11], s72 offen lds
    s_add_u32 s72, s72, 57344
    v_mfma_f32_32x32x16_bf16 v[64:79], v[132:135], v[96:99], v[64:79]
    ds_read_b64_tr_b16 v[108:109], v6 offset:6144
    ds_read_b64_tr_b16 v[208:209], v26 offset:5120
    v_mfma_f32_32x32x16_bf16 v[80:95], v[132:135], v[100:103], v[80:95]
    ds_read_b64_tr_b16 v[110:111], v6 offset:6656
    ds_read_b64_tr_b16 v[210:211], v26 offset:5376
    s_waitcnt lgkmcnt(8)
    s_add_u32 m0, s62, 3072
    s_nop 0
    buffer_load_dwordx4 v24, s[4:7], s72 offen lds
    s_waitcnt lgkmcnt(5)
    v_mfma_f32_32x32x16_bf16 v[32:47], v[136:139], v[104:107], v[32:47]
    ds_read_b64_tr_b16 v[96:97], v5 offset:8192
    ds_read_b64_tr_b16 v[212:213], v26 offset:6144
    s_waitcnt lgkmcnt(3)
    v_mfma_f32_32x32x16_bf16 v[48:63], v[136:139], v[108:111], v[48:63]
    ds_read_b64_tr_b16 v[98:99], v5 offset:8704
    ds_read_b64_tr_b16 v[214:215], v26 offset:6400
    s_add_u32 m0, s62, 4096
    s_nop 0
    buffer_load_dwordx4 v24, s[8:11], s72 offen lds
    s_add_u32 s72, s72, 57344
    v_mfma_f32_32x32x16_bf16 v[64:79], v[140:143], v[104:107], v[64:79]
    ds_read_b64_tr_b16 v[100:101], v6 offset:8192
    ds_read_b64_tr_b16 v[216:217], v26 offset:7168
    v_mfma_f32_32x32x16_bf16 v[80:95], v[140:143], v[108:111], v[80:95]
    ds_read_b64_tr_b16 v[102:103], v6 offset:8704
    ds_read_b64_tr_b16 v[218:219], v26 offset:7424
    s_waitcnt lgkmcnt(8)
    s_add_u32 m0, s62, 5120
    s_nop 0
    buffer_load_dwordx4 v24, s[4:7], s72 offen lds
    s_waitcnt lgkmcnt(5)
    v_mfma_f32_32x32x16_bf16 v[32:47], v[144:147], v[96:99], v[32:47]
    ds_read_b64_tr_b16 v[104:105], v5 offset:10240
    ds_read_b64_tr_b16 v[220:221], v27 offset:0
    s_waitcnt lgkmcnt(3)
    v_mfma_f32_32x32x16_bf16 v[48:63], v[144:147], v[100:103], v[48:63]
    ds_read_b64_tr_b16 v[106:107], v5 offset:10752
    ds_read_b64_tr_b16 v[222:223], v27 offset:256
    s_add_u32 m0, s62, 6144
    s_nop 0
    buffer_load_dwordx4 v24, s[8:11], s72 offen lds
    s_add_u32 s72, s72, 57344
    v_mfma_f32_32x32x16_bf16 v[64:79], v[148:151], v[96:99], v[64:79]
    ds_read_b64_tr_b16 v[108:109], v6 offset:10240
    ds_read_b64_tr_b16 v[224:225], v27 offset:1024
    v_mfma_f32_32x32x16_bf16 v[80:95], v[148:151], v[100:103], v[80:95]
    ds_read_b64_tr_b16 v[110:111], v6 offset:10752
    ds_read_b64_tr_b16 v[226:227], v27 offset:1280
    s_waitcnt lgkmcnt(8)
    s_add_u32 m0, s62, 7168
    s_nop 0
    buffer_load_dwordx4 v24, s[4:7], s72 offen lds
    s_waitcnt lgkmcnt(5)
    v_mfma_f32_32x32x16_bf16 v[32:47], v[152:155], v[104:107], v[32:47]
    ds_read_b64_tr_b16 v[96:97], v5 offset:12288
    ds_read_b64_tr_b16 v[228:229], v27 offset:2048
    s_waitcnt lgkmcnt(3)
    v_mfma_f32_32x32x16_bf16 v[48:63], v[152:155], v[108:111], v[48:63]
    ds_read_b64_tr_b16 v[98:99], v5 offset:12800
    ds_read_b64_tr_b16 v[230:231], v27 offset:2304
    s_add_u32 m0, s67, 0
    s_nop 0
    buffer_load_dwordx4 v24, s[8:11], s72 offen lds
    s_add_u32 s72, s72, 57344
    v_mfma_f32_32x32x16_bf16 v[64:79], v[156:159], v[104:107], v[64:79]
    ds_read_b64_tr_b16 v[100:101], v6 offset:12288
    ds_read_b64_tr_b16 v[232:233], v27 offset:3072
    v_mfma_f32_32x32x16_bf16 v[80:95], v[156:159], v[108:111], v[80:95]
    ds_read_b64_tr_b16 v[102:103], v6 offset:12800
    ds_read_b64_tr_b16 v[234:235], v27 offset:3328
    s_waitcnt lgkmcnt(8)
    s_add_u32 m0, s67, 1024
    s_nop 0
    buffer_load_dwordx4 v24, s[4:7], s72 offen lds
    s_waitcnt lgkmcnt(5)
    v_mfma_f32_32x32x16_bf16 v[32:47], v[160:163], v[96:99], v[32:47]
    ds_read_b64_tr_b16 v[104:105], v5 offset:14336
    s_waitcnt vmcnt(9)
    ds_read_b64_tr_b16 v[236:237], v26 offset:0
    s_waitcnt lgkmcnt(3)
    v_mfma_f32_32x32x16_bf16 v[48:63], v[160:163], v[100:103], v[48:63]
    ds_read_b64_tr_b16 v[106:107], v5 offset:14848
    ds_read_b64_tr_b16 v[238:239], v26 offset:256
    s_add_u32 m0, s67, 2048
    s_nop 0
    buffer_load_dwordx4 v24, s[8:11], s72 offen lds
    s_add_u32 s72, s72, 57344
    v_mfma_f32_32x32x16_bf16 v[64:79], v[164:167], v[96:99], v[64:79]
    ds_read_b64_tr_b16 v[108:109], v6 offset:14336
    s_waitcnt vmcnt(9)
    ds_read_b64_tr_b16 v[240:241], v26 offset:1024
    v_mfma_f32_32x32x16_bf16 v[80:95], v[164:167], v[100:103], v[80:95]
    ds_read_b64_tr_b16 v[110:111], v6 offset:14848
    ds_read_b64_tr_b16 v[242:243], v26 offset:1280
    s_waitcnt lgkmcnt(8)
    s_add_u32 m0, s67, 3072
    s_nop 0
    buffer_load_dwordx4 v24, s[4:7], s72 offen lds
    s_waitcnt lgkmcnt(5)
    v_mfma_f32_32x32x16_bf16 v[32:47], v[168:171], v[104:107], v[32:47]
    ds_read_b64_tr_b16 v[96:97], v5 offset:16384
    s_waitcnt vmcnt(9)
    ds_read_b64_tr_b16 v[244:245], v26 offset:2048
    s_waitcnt lgkmcnt(3)
    v_mfma_f32_32x32x16_bf16 v[48:63], v[168:171], v[108:111], v[48:63]
    ds_read_b64_tr_b16 v[98:99], v5 offset:16896
    ds_read_b64_tr_b16 v[246:247], v26 offset:2304
    s_add_u32 m0, s62, 0
    s_nop 0
    buffer_load_dwordx4 v24, s[8:11], s72 offen lds
    s_add_u32 s72, s72, 57344
    v_mfma_f32_32x32x16_bf16 v[64:79], v[172:175], v[104:107], v[64:79]
    ds_read_b64_tr_b16 v[100:101], v6 offset:16384
    s_waitcnt vmcnt(9)
    ds_read_b64_tr_b16 v[248:249], v26 offset:3072
    v_mfma_f32_32x32x16_bf16 v[80:95], v[172:175], v[108:111], v[80:95]
    ds_read_b64_tr_b16 v[102:103], v6 offset:16896
    ds_read_b64_tr_b16 v[250:251], v26 offset:3328
    s_waitcnt lgkmcnt(8)
    s_add_u32 m0, s62, 1024
    s_nop 0
    buffer_load_dwordx4 v24, s[4:7], s72 offen lds
    s_waitcnt lgkmcnt(5)
    v_mfma_f32_32x32x16_bf16 v[32:47], v[176:179], v[96:99], v[32:47]
    ds_read_b64_tr_b16 v[104:105], v5 offset:18432
    s_waitcnt vmcnt(9)
    ds_read_b64_tr_b16 v[112:113], v26 offset:4096
    s_waitcnt lgkmcnt(3)
    v_mfma_f32_32x32x16_bf16 v[48:63], v[176:179], v[100:103], v[48:63]
    ds_read_b64_tr_b16 v[106:107], v5 offset:18944
    ds_read_b64_tr_b16 v[114:115], v26 offset:4352
    s_add_u32 m0, s62, 2048
    s_nop 0
    buffer_load_dwordx4 v24, s[8:11], s72 offen lds
    s_add_u32 s72, s72, 57344
    v_mfma_f32_32x32x16_bf16 v[64:79], v[180:183], v[96:99], v[64:79]
    ds_read_b64_tr_b16 v[108:109], v6 offset:18432
    s_waitcnt vmcnt(9)
    ds_read_b64_tr_b16 v[116:117], v26 offset:5120
    v_mfma_f32_32x32x16_bf16 v[80:95], v[180:183], v[100:103], v[80:95]
    ds_read_b64_tr_b16 v[110:111], v6 offset:18944
    ds_read_b64_tr_b16 v[118:119], v26 offset:5376
    s_waitcnt lgkmcnt(8)
    s_add_u32 m0, s62, 3072
    s_nop 0
    buffer_load_dwordx4 v24, s[4:7], s72 offen lds
    buffer_load_dword v8, v7, s[52:55], 0 offen sc1
    s_waitcnt lgkmcnt(5)
    v_mfma_f32_32x32x16_bf16 v[32:47], v[184:187], v[104:107], v[32:47]
    ds_read_b64_tr_b16 v[96:97], v5 offset:20480
    s_waitcnt vmcnt(10)
    ds_read_b64_tr_b16 v[120:121], v26 offset:6144
    s_waitcnt lgkmcnt(3)
    v_mfma_f32_32x32x16_bf16 v[48:63], v[184:187], v[108:111], v[48:63]
    ds_read_b64_tr_b16 v[98:99], v5 offset:20992
    ds_read_b64_tr_b16 v[122:123], v26 offset:6400
    s_add_u32 m0, s62, 4096
    s_nop 0
    buffer_load_dwordx4 v24, s[8:11], s72 offen lds
    s_add_u32 s72, s72, 57344
    v_mfma_f32_32x32x16_bf16 v[64:79], v[188:191], v[104:107], v[64:79]
    ds_read_b64_tr_b16 v[100:101], v6 offset:20480
    s_waitcnt vmcnt(10)
    ds_read_b64_tr_b16 v[124:125], v26 offset:7168
    v_mfma_f32_32x32x16_bf16 v[80:95], v[188:191], v[108:111], v[80:95]
    ds_read_b64_tr_b16 v[102:103], v6 offset:20992
    ds_read_b64_tr_b16 v[126:127], v26 offset:7424
    s_waitcnt lgkmcnt(8)
    s_add_u32 m0, s62, 5120
    s_nop 0
    buffer_load_dwordx4 v24, s[4:7], s72 offen lds
    s_waitcnt lgkmcnt(5)
    v_mfma_f32_32x32x16_bf16 v[32:47], v[192:195], v[96:99], v[32:47]
    ds_read_b64_tr_b16 v[104:105], v5 offset:22528
    s_waitcnt vmcnt(10)
    ds_read_b64_tr_b16 v[128:129], v27 offset:0
    s_waitcnt lgkmcnt(3)
    v_mfma_f32_32x32x16_bf16 v[48:63], v[192:195], v[100:103], v[48:63]
    ds_read_b64_tr_b16 v[106:107], v5 offset:23040
    ds_read_b64_tr_b16 v[130:131], v27 offset:256
    s_add_u32 m0, s62, 6144
    s_nop 0
    buffer_load_dwordx4 v24, s[8:11], s72 offen lds
    s_add_u32 s72, s72, 57344
    v_mfma_f32_32x32x16_bf16 v[64:79], v[196:199], v[96:99], v[64:79]
    ds_read_b64_tr_b16 v[108:109], v6 offset:22528
    s_waitcnt vmcnt(10)
    ds_read_b64_tr_b16 v[132:133], v27 offset:1024
    v_mfma_f32_32x32x16_bf16 v[80:95], v[196:199], v[100:103], v[80:95]
    ds_read_b64_tr_b16 v[110:111], v6 offset:23040
    ds_read_b64_tr_b16 v[134:135], v27 offset:1280
    s_waitcnt lgkmcnt(8)
    s_add_u32 m0, s62, 7168
    s_nop 0
    buffer_load_dwordx4 v24, s[4:7], s72 offen lds
    s_waitcnt lgkmcnt(5)
    v_mfma_f32_32x32x16_bf16 v[32:47], v[200:203], v[104:107], v[32:47]
    ds_read_b64_tr_b16 v[96:97], v5 offset:24576
    s_waitcnt vmcnt(10)
    ds_read_b64_tr_b16 v[136:137], v27 offset:2048
    s_waitcnt lgkmcnt(3)
    v_mfma_f32_32x32x16_bf16 v[48:63], v[200:203], v[108:111], v[48:63]
    ds_read_b64_tr_b16 v[98:99], v5 offset:25088
    ds_read_b64_tr_b16 v[138:139], v27 offset:2304
    s_add_u32 m0, s67, 0
    s_nop 0
    buffer_load_dwordx4 v24, s[8:11], s72 offen lds
    s_add_u32 s72, s72, 57344
    v_mfma_f32_32x32x16_bf16 v[64:79], v[204:207], v[104:107], v[64:79]
    ds_read_b64_tr_b16 v[100:101], v6 offset:24576
    s_waitcnt vmcnt(10)
    ds_read_b64_tr_b16 v[140:141], v27 offset:3072
    v_mfma_f32_32x32x16_bf16 v[80:95], v[204:207], v[108:111], v[80:95]
    ds_read_b64_tr_b16 v[102:103], v6 offset:25088
    ds_read_b64_tr_b16 v[142:143], v27 offset:3328
    s_waitcnt lgkmcnt(8)
    s_add_u32 m0, s67, 1024
    s_nop 0
    buffer_load_dwordx4 v24, s[4:7], s72 offen lds
    s_waitcnt lgkmcnt(5)
    v_mfma_f32_32x32x16_bf16 v[32:47], v[208:211], v[96:99], v[32:47]
    ds_read_b64_tr_b16 v[104:105], v5 offset:26624
    s_waitcnt vmcnt(10)
    ds_read_b64_tr_b16 v[144:145], v26 offset:0
    s_waitcnt lgkmcnt(3)
    v_mfma_f32_32x32x16_bf16 v[48:63], v[208:211], v[100:103], v[48:63]
    ds_read_b64_tr_b16 v[106:107], v5 offset:27136
    ds_read_b64_tr_b16 v[146:147], v26 offset:256
    s_add_u32 m0, s67, 2048
    s_nop 0
    buffer_load_dwordx4 v24, s[8:11], s72 offen lds
    s_add_u32 s72, s72, 57344
    v_mfma_f32_32x32x16_bf16 v[64:79], v[212:215], v[96:99], v[64:79]
    ds_read_b64_tr_b16 v[108:109], v6 offset:26624
    s_waitcnt vmcnt(10)
    ds_read_b64_tr_b16 v[148:149], v26 offset:1024
    v_mfma_f32_32x32x16_bf16 v[80:95], v[212:215], v[100:103], v[80:95]
    ds_read_b64_tr_b16 v[110:111], v6 offset:27136
    ds_read_b64_tr_b16 v[150:151], v26 offset:1280
    s_waitcnt lgkmcnt(8)
    s_add_u32 m0, s67, 3072
    s_nop 0
    buffer_load_dwordx4 v24, s[4:7], s72 offen lds
    s_waitcnt vmcnt(8)
    v_cmp_ne_u32 vcc, s60, v8
    s_nop 4
    s_cbranch_vccz L_dok
    s_mov_b32 s87, 0
L_poll3:
    buffer_load_dword v8, v7, s[52:55], 0 offen sc1
    s_waitcnt vmcnt(0)
    v_cmp_ne_u32 vcc, s60, v8
    s_nop 4
    s_cbranch_vccz L_pdone3
    s_sleep 2
    s_add_u32 s87, s87, 1
    s_cmp_lt_u32 s87, 20000
    s_cbranch_scc1 L_poll3
L_pdone3:
L_dok:
    s_waitcnt lgkmcnt(5)
    v_mfma_f32_32x32x16_bf16 v[32:47], v[216:219], v[104:107], v[32:47]
    ds_read_b64_tr_b16 v[96:97], v5 offset:28672
    ds_read_b64_tr_b16 v[152:153], v26 offset:2048
    s_waitcnt lgkmcnt(3)
    v_mfma_f32_32x32x16_bf16 v[48:63], v[216:219], v[108:111], v[48:63]
    ds_read_b64_tr_b16 v[98:99], v5 offset:29184
    ds_read_b64_tr_b16 v[154:155], v26 offset:2304
    s_add_u32 m0, s62, 0
    s_nop 0
    buffer_load_dwordx4 v24, s[8:11], s72 offen lds
    s_add_u32 s72, s72, 57344
    buffer_load_dwordx4 v[204:207], v2, s[52:55], s73 offen offset:0 sc1
    v_mfma_f32_32x32x16_bf16 v[64:79], v[220:223], v[104:107], v[64:79]
    ds_read_b64_tr_b16 v[100:101], v6 offset:28672
    ds_read_b64_tr_b16 v[156:157], v26 offset:3072
    v_mfma_f32_32x32x16_bf16 v[80:95], v[220:223], v[108:111], v[80:95]
    ds_read_b64_tr_b16 v[102:103], v6 offset:29184
    ds_read_b64_tr_b16 v[158:159], v26 offset:3328
    buffer_load_dwordx4 v[208:211], v2, s[52:55], s73 offen offset:1024 sc1
    s_waitcnt lgkmcnt(5)
    v_mfma_f32_32x32x16_bf16 v[32:47], v[224:227], v[96:99], v[32:47]
    ds_read_b64_tr_b16 v[104:105], v5 offset:30720
    s_waitcnt vmcnt(10)
    ds_read_b64_tr_b16 v[160:161], v26 offset:4096
    s_waitcnt lgkmcnt(3)
    v_mfma_f32_32x32x16_bf16 v[48:63], v[224:227], v[100:103], v[48:63]
    ds_read_b64_tr_b16 v[106:107], v5 offset:31232
    ds_read_b64_tr_b16 v[162:163], v26 offset:4352
    buffer_load_dwordx4 v[212:215], v2, s[52:55], s73 offen offset:2048 sc1
    v_mfma_f32_32x32x16_bf16 v[64:79], v[228:231], v[96:99], v[64:79]
    ds_read_b64_tr_b16 v[108:109], v6 offset:30720
    s_waitcnt vmcnt(10)
    ds_read_b64_tr_b16 v[164:165], v26 offset:5120
    v_mfma_f32_32x32x16_bf16 v[80:95], v[228:231], v[100:103], v[80:95]
    ds_read_b64_tr_b16 v[110:111], v6 offset:31232
    ds_read_b64_tr_b16 v[166:167], v26 offset:5376
    buffer_load_dwordx4 v[216:219], v2, s[52:55], s73 offen offset:3072 sc1
    s_waitcnt lgkmcnt(5)
    v_mfma_f32_32x32x16_bf16 v[32:47], v[232:235], v[104:107], v[32:47]
    ds_read_b64_tr_b16 v[96:97], v5 offset:32768
    s_waitcnt vmcnt(10)
    ds_read_b64_tr_b16 v[168:169], v26 offset:6144
    s_waitcnt lgkmcnt(3)
    v_mfma_f32_32x32x16_bf16 v[48:63], v[232:235], v[108:111], v[48:63]
    ds_read_b64_tr_b16 v[98:99], v5 offset:33280
    ds_read_b64_tr_b16 v[170:171], v26 offset:6400
    s_add_u32 s73, s73, 4096
    buffer_load_dwordx4 v[220:223], v2, s[52:55], s73 offen offset:0 sc1
    v_mfma_f32_32x32x16_bf16 v[64:79], v[236:239], v[104:107], v[64:79]
    ds_read_b64_tr_b16 v[100:101], v6 offset:32768
    s_waitcnt vmcnt(10)
    ds_read_b64_tr_b16 v[172:173], v26 offset:7168
    v_mfma_f32_32x32x16_bf16 v[80:95], v[236:239], v[108:111], v[80:95]
    ds_read_b64_tr_b16 v[102:103], v6 offset:33280
    ds_read_b64_tr_b16 v[174:175], v26 offset:7424
    buffer_load_dwordx4 v[224:227], v2, s[52:55], s73 offen offset:1024 sc1
    s_waitcnt lgkmcnt(5)
    v_mfma_f32_32x32x16_bf16 v[32:47], v[240:243], v[96:99], v[32:47]
    ds_read_b64_tr_b16 v[104:105], v5 offset:34816
    s_waitcnt vmcnt(10)
    ds_read_b64_tr_b16 v[176:177], v27 offset:0
    s_waitcnt lgkmcnt(3)
    v_mfma_f32_32x32x16_bf16 v[48:63], v[240:243], v[100:103], v[48:63]
    ds_read_b64_tr_b16 v[106:107], v5 offset:35328
    ds_read_b64_tr_b16 v[178:179], v27 offset:256
    buffer_load_dwordx4 v[228:231], v2, s[52:55], s73 offen offset:2048 sc1
    v_mfma_f32_32x32x16_bf16 v[64:79], v[244:247], v[96:99], v[64:79]
    ds_read_b64_tr_b16 v[108:109], v6 offset:34816
    s_waitcnt vmcnt(10)
    ds_read_b64_tr_b16 v[180:181], v27 offset:1024
    v_mfma_f32_32x32x16_bf16 v[80:95], v[244:247], v[100:103], v[80:95]
    ds_read_b64_tr_b16 v[110:111], v6 offset:35328
    ds_read_b64_tr_b16 v[182:183], v27 offset:1280
    buffer_load_dwordx4 v[232:235], v2, s[52:55], s73 offen offset:3072 sc1
    s_waitcnt lgkmcnt(5)
    v_mfma_f32_32x32x16_bf16 v[32:47], v[248:251], v[104:107], v[32:47]
    ds_read_b64_tr_b16 v[96:97], v5 offset:36864
    s_waitcnt vmcnt(10)
    ds_read_b64_tr_b16 v[184:185], v27 offset:2048
    s_waitcnt lgkmcnt(3)
    v_mfma_f32_32x32x16_bf16 v[48:63], v[248:251], v[108:111], v[48:63]
    ds_read_b64_tr_b16 v[98:99], v5 offset:37376
    ds_read_b64_tr_b16 v[186:187], v27 offset:2304
    buffer_load_dwordx4 v[236:239], v2, s[52:55], s74 offen offset:0 sc1
    v_mfma_f32_32x32x16_bf16 v[64:79], v[112:115], v[104:107], v[64:79]
    ds_read_b64_tr_b16 v[100:101], v6 offset:36864
    s_waitcnt vmcnt(10)
    ds_read_b64_tr_b16 v[188:189], v27 offset:3072
    v_mfma_f32_32x32x16_bf16 v[80:95], v[112:115], v[108:111], v[80:95]
    ds_read_b64_tr_b16 v[102:103], v6 offset:37376
    ds_read_b64_tr_b16 v[190:191], v27 offset:3328
    buffer_load_dwordx4 v[240:243], v2, s[52:55], s74 offen offset:1024 sc1
    buffer_load_dwordx2 v[10:11], v9, s[52:55], s88 offen sc1
    buffer_load_dwordx4 v[196:199], v2, s[52:55], s86 offen offset:0 sc1
    buffer_load_dwordx4 v[200:203], v2, s[52:55], s86 offen offset:1024 sc1
    s_waitcnt lgkmcnt(5)
    v_mfma_f32_32x32x16_bf16 v[32:47], v[116:119], v[96:99], v[32:47]
    ds_read_b64_tr_b16 v[104:105], v5 offset:38912
    s_waitcnt vmcnt(13)
    ds_read_b64_tr_b16 v[192:193], v26 offset:0
    s_waitcnt lgkmcnt(3)
    v_mfma_f32_32x32x16_bf16 v[48:63], v[116:119], v[100:103], v[48:63]
    ds_read_b64_tr_b16 v[106:107], v5 offset:39424
    ds_read_b64_tr_b16 v[194:195], v26 offset:256
    buffer_load_dwordx4 v[244:247], v2, s[52:55], s74 offen offset:2048 sc1
    v_mfma_f32_32x32x16_bf16 v[64:79], v[120:123], v[96:99], v[64:79]
    ds_read_b64_tr_b16 v[108:109], v6 offset:38912
    v_mfma_f32_32x32x16_bf16 v[80:95], v[120:123], v[100:103], v[80:95]
    ds_read_b64_tr_b16 v[110:111], v6 offset:39424
    buffer_load_dwordx4 v[248:251], v2, s[52:55], s74 offen offset:3072 sc1
    s_waitcnt lgkmcnt(3)
    v_mfma_f32_32x32x16_bf16 v[32:47], v[124:127], v[104:107], v[32:47]
    ds_read_b64_tr_b16 v[96:97], v5 offset:40960
    s_waitcnt lgkmcnt(1)
    v_mfma_f32_32x32x16_bf16 v[48:63], v[124:127], v[108:111], v[48:63]
    ds_read_b64_tr_b16 v[98:99], v5 offset:41472
    v_mfma_f32_32x32x16_bf16 v[64:79], v[128:131], v[104:107], v[64:79]
    ds_read_b64_tr_b16 v[100:101], v6 offset:40960
    v_mfma_f32_32x32x16_bf16 v[80:95], v[128:131], v[108:111], v[80:95]
    ds_read_b64_tr_b16 v[102:103], v6 offset:41472
    s_waitcnt lgkmcnt(2)
    v_mfma_f32_32x32x16_bf16 v[32:47], v[132:135], v[96:99], v[32:47]
    ds_read_b64_tr_b16 v[104:105], v5 offset:43008
    s_waitcnt lgkmcnt(1)
    v_mfma_f32_32x32x16_bf16 v[48:63], v[132:135], v[100:103], v[48:63]
    ds_read_b64_tr_b16 v[106:107], v5 offset:43520
    v_mfma_f32_32x32x16_bf16 v[64:79], v[136:139], v[96:99], v[64:79]
    ds_read_b64_tr_b16 v[108:109], v6 offset:43008
    v_mfma_f32_32x32x16_bf16 v[80:95], v[136:139], v[100:103], v[80:95]
    ds_read_b64_tr_b16 v[110:111], v6 offset:43520
    s_waitcnt lgkmcnt(2)
    v_mfma_f32_32x32x16_bf16 v[32:47], v[140:143], v[104:107], v[32:47]
    ds_read_b64_tr_b16 v[96:97], v5 offset:45056
    s_waitcnt lgkmcnt(1)
    v_mfma_f32_32x32x16_bf16 v[48:63], v[140:143], v[108:111], v[48:63]
    ds_read_b64_tr_b16 v[98:99], v5 offset:45568
    v_mfma_f32_32x32x16_bf16 v[64:79], v[144:147], v[104:107], v[64:79]
    ds_read_b64_tr_b16 v[100:101], v6 offset:45056
    v_mfma_f32_32x32x16_bf16 v[80:95], v[144:147], v[108:111], v[80:95]
    ds_read_b64_tr_b16 v[102:103], v6 offset:45568
    s_waitcnt lgkmcnt(2)
    v_mfma_f32_32x32x16_bf16 v[32:47], v[148:151], v[96:99], v[32:47]
    ds_read_b64_tr_b16 v[104:105], v5 offset:47104
    s_waitcnt lgkmcnt(1)
    v_mfma_f32_32x32x16_bf16 v[48:63], v[148:151], v[100:103], v[48:63]
    ds_read_b64_tr_b16 v[106:107], v5 offset:47616
    v_mfma_f32_32x32x16_bf16 v[64:79], v[152:155], v[96:99], v[64:79]
    ds_read_b64_tr_b16 v[108:109], v6 offset:47104
    v_mfma_f32_32x32x16_bf16 v[80:95], v[152:155], v[100:103], v[80:95]
    ds_read_b64_tr_b16 v[110:111], v6 offset:47616
    s_waitcnt vmcnt(3)
    v_xor_b32 v12, s60, v197
    v_xor_b32 v13, s60, v199
    s_waitcnt vmcnt(2)
    v_xor_b32 v14, s60, v201
    v_xor_b32 v15, s60, v203
    v_or3_b32 v12, v12, v13, v14
    v_or_b32 v12, v12, v15
    v_cmp_ne_u32 vcc, 0, v12
    s_nop 4
    s_cbranch_vccz L_cok
    s_mov_b32 s87, 0
L_poll4:
    buffer_load_dwordx4 v[196:199], v2, s[52:55], s86 offen offset:0 sc1
    buffer_load_dwordx4 v[200:203], v2, s[52:55], s86 offen offset:1024 sc1
    s_waitcnt vmcnt(0)
    v_xor_b32 v12, s60, v197
    v_xor_b32 v13, s60, v199
    v_xor_b32 v14, s60, v201
    v_xor_b32 v15, s60, v203
    v_or3_b32 v12, v12, v13, v14
    v_or_b32 v12, v12, v15
    v_cmp_ne_u32 vcc, 0, v12
    s_nop 4
    s_cbranch_vccz L_pdone4
    s_sleep 1
    s_add_u32 s87, s87, 1
    s_cmp_lt_u32 s87, 20000
    s_cbranch_scc1 L_poll4
L_pdone4:
L_cok:
    s_waitcnt lgkmcnt(2)
    v_mfma_f32_32x32x16_bf16 v[32:47], v[156:159], v[104:107], v[32:47]
    ds_read_b64_tr_b16 v[96:97], v5 offset:49152
    v_mov_b32 v197, 0
    s_waitcnt lgkmcnt(1)
    v_mfma_f32_32x32x16_bf16 v[48:63], v[156:159], v[108:111], v[48:63]
    ds_read_b64_tr_b16 v[98:99], v5 offset:49664
    v_mov_b32 v199, 0
    v_mfma_f32_32x32x16_bf16 v[64:79], v[160:163], v[104:107], v[64:79]
    ds_read_b64_tr_b16 v[100:101], v6 offset:49152
    v_mov_b32 v201, 0
    v_mfma_f32_32x32x16_bf16 v[80:95], v[160:163], v[108:111], v[80:95]
    ds_read_b64_tr_b16 v[102:103], v6 offset:49664
    v_mov_b32 v203, 0
    v_cmp_ne_u32 vcc, s60, v11
    s_nop 4
    s_cbranch_vccz L_st2ok
    s_mov_b32 s87, 0
L_poll5:
    buffer_load_dwordx2 v[10:11], v9, s[52:55], s88 offen sc1
    s_waitcnt vmcnt(0)
    v_cmp_ne_u32 vcc, s60, v11
    s_nop 4
    s_cbranch_vccz L_pdone5
    s_sleep 1
    s_add_u32 s87, s87, 1
    s_cmp_lt_u32 s87, 20000
    s_cbranch_scc1 L_poll5
L_pdone5:
L_st2ok:
    s_waitcnt lgkmcnt(2)
    v_mfma_f32_32x32x16_bf16 v[32:47], v[164:167], v[96:99], v[32:47]
    ds_read_b64_tr_b16 v[104:105], v5 offset:51200
    v_mov_b32 v12, v10
    s_waitcnt lgkmcnt(1)
    v_mfma_f32_32x32x16_bf16 v[48:63], v[164:167], v[100:103], v[48:63]
    ds_read_b64_tr_b16 v[106:107], v5 offset:51712
    v_lshlrev_b32 v13, 4, v1
    v_mfma_f32_32x32x16_bf16 v[64:79], v[168:171], v[96:99], v[64:79]
    ds_read_b64_tr_b16 v[108:109], v6 offset:51200
    v_permlane32_swap_b32 v10, v12
    v_mfma_f32_32x32x16_bf16 v[80:95], v[168:171], v[100:103], v[80:95]
    ds_read_b64_tr_b16 v[110:111], v6 offset:51712
    v_and_b32 v14, 0xf00, v13
    s_waitcnt lgkmcnt(2)
    v_mfma_f32_32x32x16_bf16 v[32:47], v[172:175], v[104:107], v[32:47]
    ds_read_b64_tr_b16 v[96:97], v5 offset:53248
    v_and_b32 v15, 0xffff0000, v10
    v_lshrrev_b32 v18, 16, v10
    s_waitcnt lgkmcnt(1)
    v_mfma_f32_32x32x16_bf16 v[48:63], v[172:175], v[108:111], v[48:63]
    ds_read_b64_tr_b16 v[98:99], v5 offset:53760
    v_and_b32 v16, 0xffff, v10
    v_mul_f32 v11, v15, v15
    v_mfma_f32_32x32x16_bf16 v[64:79], v[176:179], v[104:107], v[64:79]
    ds_read_b64_tr_b16 v[100:101], v6 offset:53248
    v_or_b32 v18, v18, v15
    v_lshl_or_b32 v16, v10, 16, v16
    v_mfma_f32_32x32x16_bf16 v[80:95], v[176:179], v[108:111], v[80:95]
    ds_read_b64_tr_b16 v[102:103], v6 offset:53760
    v_rcp_f32 v10, v11
    s_add_u32 s74, s74, 4096
    buffer_load_dwordx4 v[176:179], v2, s[52:55], s74 offen offset:0 sc1
    s_waitcnt lgkmcnt(2)
    v_mfma_f32_32x32x16_bf16 v[32:47], v[180:183], v[96:99], v[32:47]
    ds_read_b64_tr_b16 v[104:105], v5 offset:55296
    v_and_b32 v15, 0xffff0000, v12
    v_lshrrev_b32 v22, 16, v12
    s_waitcnt lgkmcnt(1)
    v_mfma_f32_32x32x16_bf16 v[48:63], v[180:183], v[100:103], v[48:63]
    ds_read_b64_tr_b16 v[106:107], v5 offset:55808
    v_and_b32 v20, 0xffff, v12
    v_mul_f32 v11, v15, v15
    buffer_load_dwordx4 v[180:183], v2, s[52:55], s74 offen offset:1024 sc1
    v_mfma_f32_32x32x16_bf16 v[64:79], v[184:187], v[96:99], v[64:79]
    ds_read_b64_tr_b16 v[108:109], v6 offset:55296
    v_or_b32 v22, v22, v15
    v_lshl_or_b32 v20, v12, 16, v20
    v_mfma_f32_32x32x16_bf16 v[80:95], v[184:187], v[100:103], v[80:95]
    ds_read_b64_tr_b16 v[110:111], v6 offset:55808
    v_rcp_f32 v12, v11
    buffer_load_dwordx4 v[184:187], v2, s[52:55], s74 offen offset:2048 sc1
    s_waitcnt lgkmcnt(2)
    v_mfma_f32_32x32x16_bf16 v[32:47], v[188:191], v[104:107], v[32:47]
    v_and_b32 v13, 0xf0, v13
    v_and_b32 v15, 0x100, v14
    v_lshl_add_u32 v13, v15, 2, v13
    s_waitcnt lgkmcnt(0)
    v_mfma_f32_32x32x16_bf16 v[48:63], v[188:191], v[108:111], v[48:63]
    v_lshrrev_b32 v14, 9, v14
    v_lshl_add_u32 v14, v14, 8, v13
    s_lshl_b32 s81, s3, 12
    buffer_load_dwordx4 v[188:191], v2, s[52:55], s74 offen offset:3072 sc1
    v_mfma_f32_32x32x16_bf16 v[64:79], v[192:195], v[104:107], v[64:79]
    s_add_u32 s81, s81, 122880
    v_add_u32 v14, s81, v14
    v_add_u32 v15, 122880, v2
    v_mfma_f32_32x32x16_bf16 v[80:95], v[192:195], v[108:111], v[80:95]
    buffer_load_dwordx4 v[192:195], v2, s[52:55], s75 offen offset:0 sc1
    v_mfma_f32_32x32x16_bf16 v[32:47], v[196:199], v[16:19], v[32:47]
    v_mfma_f32_32x32x16_bf16 v[48:63], v[196:199], v[20:23], v[48:63]
    buffer_load_dwordx4 v[196:199], v2, s[52:55], s75 offen offset:1024 sc1
    v_mfma_f32_32x32x16_bf16 v[64:79], v[200:203], v[16:19], v[64:79]
    v_mfma_f32_32x32x16_bf16 v[80:95], v[200:203], v[20:23], v[80:95]
    buffer_load_dwordx4 v[200:203], v2, s[52:55], s75 offen offset:2048 sc1
    s_nop 9
    v_pk_mul_f32 v[32:33], v[32:33], v[64:65]
    v_pk_mul_f32 v[34:35], v[34:35], v[66:67]
    v_pk_mul_f32 v[36:37], v[36:37], v[68:69]
    v_pk_mul_f32 v[38:39], v[38:39], v[70:71]
    v_pk_mul_f32 v[40:41], v[40:41], v[72:73]
    v_pk_mul_f32 v[42:43], v[42:43], v[74:75]
    v_pk_mul_f32 v[44:45], v[44:45], v[76:77]
    v_pk_mul_f32 v[46:47], v[46:47], v[78:79]
    v_pk_mul_f32 v[32:33], v[32:33], v[10:11] op_sel_hi:[1,0]
    v_pk_mul_f32 v[34:35], v[34:35], v[10:11] op_sel_hi:[1,0]
    v_pk_mul_f32 v[36:37], v[36:37], v[10:11] op_sel_hi:[1,0]
    v_pk_mul_f32 v[38:39], v[38:39], v[10:11] op_sel_hi:[1,0]
    v_pk_mul_f32 v[40:41], v[40:41], v[10:11] op_sel_hi:[1,0]
    v_pk_mul_f32 v[42:43], v[42:43], v[10:11] op_sel_hi:[1,0]
    v_pk_mul_f32 v[44:45], v[44:45], v[10:11] op_sel_hi:[1,0]
    v_pk_mul_f32 v[46:47], v[46:47], v[10:11] op_sel_hi:[1,0]
    v_cvt_pk_bf16_f32 v64, v32, v33
    v_cvt_pk_bf16_f32 v65, v34, v35
    v_cvt_pk_bf16_f32 v66, v36, v37
    v_cvt_pk_bf16_f32 v67, v38, v39
    v_cvt_pk_bf16_f32 v68, v40, v41
    v_cvt_pk_bf16_f32 v69, v42, v43
    v_cvt_pk_bf16_f32 v70, v44, v45
    v_cvt_pk_bf16_f32 v71, v46, v47
    ds_write_b128 v14, v[64:67] offset:0
    ds_write_b128 v14, v[68:71] offset:512
    v_pk_mul_f32 v[48:49], v[48:49], v[80:81]
    v_pk_mul_f32 v[50:51], v[50:51], v[82:83]
    v_pk_mul_f32 v[52:53], v[52:53], v[84:85]
    v_pk_mul_f32 v[54:55], v[54:55], v[86:87]
    v_pk_mul_f32 v[56:57], v[56:57], v[88:89]
    v_pk_mul_f32 v[58:59], v[58:59], v[90:91]
    v_pk_mul_f32 v[60:61], v[60:61], v[92:93]
    v_pk_mul_f32 v[62:63], v[62:63], v[94:95]
    v_pk_mul_f32 v[48:49], v[48:49], v[12:13] op_sel_hi:[1,0]
    v_pk_mul_f32 v[50:51], v[50:51], v[12:13] op_sel_hi:[1,0]
    v_pk_mul_f32 v[52:53], v[52:53], v[12:13] op_sel_hi:[1,0]
    v_pk_mul_f32 v[54:55], v[54:55], v[12:13] op_sel_hi:[1,0]
    v_pk_mul_f32 v[56:57], v[56:57], v[12:13] op_sel_hi:[1,0]
    v_pk_mul_f32 v[58:59], v[58:59], v[12:13] op_sel_hi:[1,0]
    v_pk_mul_f32 v[60:61], v[60:61], v[12:13] op_sel_hi:[1,0]
    v_pk_mul_f32 v[62:63], v[62:63], v[12:13] op_sel_hi:[1,0]
    v_cvt_pk_bf16_f32 v80, v48, v49
    v_cvt_pk_bf16_f32 v81, v50, v51
    v_cvt_pk_bf16_f32 v82, v52, v53
    v_cvt_pk_bf16_f32 v83, v54, v55
    v_cvt_pk_bf16_f32 v84, v56, v57
    v_cvt_pk_bf16_f32 v85, v58, v59
    v_cvt_pk_bf16_f32 v86, v60, v61
    v_cvt_pk_bf16_f32 v87, v62, v63
    ds_write_b128 v14, v[80:83] offset:2048
    ds_write_b128 v14, v[84:87] offset:2560
    s_waitcnt lgkmcnt(0)
    s_barrier
    ds_read_b128 v[32:35], v15 offset:0
    ds_read_b128 v[36:39], v15 offset:1024
    ds_read_b128 v[40:43], v15 offset:2048
    ds_read_b128 v[44:47], v15 offset:3072
    ds_read_b128 v[48:51], v15 offset:4096
    ds_read_b128 v[52:55], v15 offset:5120
    ds_read_b128 v[56:59], v15 offset:6144
    ds_read_b128 v[60:63], v15 offset:7168
    ds_read_b128 v[64:67], v15 offset:8192
    ds_read_b128 v[68:71], v15 offset:9216
    ds_read_b128 v[72:75], v15 offset:10240
    ds_read_b128 v[76:79], v15 offset:11264
    s_waitcnt lgkmcnt(11)
    v_mfma_f32_16x16x32_bf16 v[160:163], v[204:207], v[32:35], 0
    ds_read_b128 v[80:83], v15 offset:12288
    s_waitcnt lgkmcnt(11)
    v_mfma_f32_16x16x32_bf16 v[164:167], v[204:207], v[36:39], 0
    ds_read_b128 v[84:87], v15 offset:13312
    s_waitcnt lgkmcnt(11)
    v_mfma_f32_16x16x32_bf16 v[168:171], v[204:207], v[40:43], 0
    ds_read_b128 v[88:91], v15 offset:14336
    s_waitcnt lgkmcnt(11)
    v_mfma_f32_16x16x32_bf16 v[172:175], v[204:207], v[44:47], 0
    ds_read_b128 v[92:95], v15 offset:15360
    buffer_load_dwordx4 v[204:207], v2, s[52:55], s75 offen offset:3072 sc1
    s_waitcnt lgkmcnt(11)
    v_mfma_f32_16x16x32_bf16 v[160:163], v[208:211], v[48:51], v[160:163]
    ds_read_b128 v[96:99], v15 offset:16384
    s_waitcnt lgkmcnt(11)
    v_mfma_f32_16x16x32_bf16 v[164:167], v[208:211], v[52:55], v[164:167]
    ds_read_b128 v[100:103], v15 offset:17408
    s_waitcnt lgkmcnt(11)
    v_mfma_f32_16x16x32_bf16 v[168:171], v[208:211], v[56:59], v[168:171]
    ds_read_b128 v[104:107], v15 offset:18432
    s_waitcnt lgkmcnt(11)
    v_mfma_f32_16x16x32_bf16 v[172:175], v[208:211], v[60:63], v[172:175]
    ds_read_b128 v[108:111], v15 offset:19456
    s_add_u32 s75, s75, 4096
    buffer_load_dwordx4 v[208:211], v2, s[52:55], s75 offen offset:0 sc1
    s_waitcnt lgkmcnt(11)
    v_mfma_f32_16x16x32_bf16 v[160:163], v[212:215], v[64:67], v[160:163]
    ds_read_b128 v[112:115], v15 offset:20480
    s_waitcnt lgkmcnt(11)
    v_mfma_f32_16x16x32_bf16 v[164:167], v[212:215], v[68:71], v[164:167]
    ds_read_b128 v[116:119], v15 offset:21504
    s_waitcnt lgkmcnt(11)
    v_mfma_f32_16x16x32_bf16 v[168:171], v[212:215], v[72:75], v[168:171]
    ds_read_b128 v[120:123], v15 offset:22528
    s_waitcnt lgkmcnt(11)
    v_mfma_f32_16x16x32_bf16 v[172:175], v[212:215], v[76:79], v[172:175]
    ds_read_b128 v[124:127], v15 offset:23552
    buffer_load_dwordx4 v[212:215], v2, s[52:55], s75 offen offset:1024 sc1
    s_waitcnt lgkmcnt(11)
    v_mfma_f32_16x16x32_bf16 v[160:163], v[216:219], v[80:83], v[160:163]
    ds_read_b128 v[128:131], v15 offset:24576
    s_waitcnt lgkmcnt(11)
    v_mfma_f32_16x16x32_bf16 v[164:167], v[216:219], v[84:87], v[164:167]
    ds_read_b128 v[132:135], v15 offset:25600
    s_waitcnt lgkmcnt(11)
    v_mfma_f32_16x16x32_bf16 v[168:171], v[216:219], v[88:91], v[168:171]
    ds_read_b128 v[136:139], v15 offset:26624
    s_waitcnt lgkmcnt(11)
    v_mfma_f32_16x16x32_bf16 v[172:175], v[216:219], v[92:95], v[172:175]
    ds_read_b128 v[140:143], v15 offset:27648
    buffer_load_dwordx4 v[216:219], v2, s[52:55], s75 offen offset:2048 sc1
    s_waitcnt lgkmcnt(11)
    v_mfma_f32_16x16x32_bf16 v[160:163], v[220:223], v[96:99], v[160:163]
    ds_read_b128 v[144:147], v15 offset:28672
    s_waitcnt lgkmcnt(11)
    v_mfma_f32_16x16x32_bf16 v[164:167], v[220:223], v[100:103], v[164:167]
    ds_read_b128 v[148:151], v15 offset:29696
    s_waitcnt lgkmcnt(11)
    v_mfma_f32_16x16x32_bf16 v[168:171], v[220:223], v[104:107], v[168:171]
    ds_read_b128 v[152:155], v15 offset:30720
    s_waitcnt lgkmcnt(11)
    v_mfma_f32_16x16x32_bf16 v[172:175], v[220:223], v[108:111], v[172:175]
    ds_read_b128 v[156:159], v15 offset:31744
    buffer_load_dwordx4 v[220:223], v2, s[52:55], s75 offen offset:3072 sc1
    s_waitcnt lgkmcnt(11)
    v_mfma_f32_16x16x32_bf16 v[160:163], v[224:227], v[112:115], v[160:163]
    s_waitcnt lgkmcnt(10)
    v_mfma_f32_16x16x32_bf16 v[164:167], v[224:227], v[116:119], v[164:167]
    s_waitcnt lgkmcnt(9)
    v_mfma_f32_16x16x32_bf16 v[168:171], v[224:227], v[120:123], v[168:171]
    s_waitcnt lgkmcnt(8)
    v_mfma_f32_16x16x32_bf16 v[172:175], v[224:227], v[124:127], v[172:175]
    buffer_load_dwordx4 v[224:227], v3, s[52:55], s76 offen offset:0 sc1
    s_waitcnt lgkmcnt(7)
    v_mfma_f32_16x16x32_bf16 v[160:163], v[228:231], v[128:131], v[160:163]
    s_waitcnt lgkmcnt(6)
    v_mfma_f32_16x16x32_bf16 v[164:167], v[228:231], v[132:135], v[164:167]
    s_waitcnt lgkmcnt(5)
    v_mfma_f32_16x16x32_bf16 v[168:171], v[228:231], v[136:139], v[168:171]
    s_waitcnt lgkmcnt(4)
    v_mfma_f32_16x16x32_bf16 v[172:175], v[228:231], v[140:143], v[172:175]
    buffer_load_dwordx4 v[228:231], v3, s[52:55], s76 offen offset:1024 sc1
    s_waitcnt lgkmcnt(3)
    v_mfma_f32_16x16x32_bf16 v[160:163], v[232:235], v[144:147], v[160:163]
    s_waitcnt lgkmcnt(2)
    v_mfma_f32_16x16x32_bf16 v[164:167], v[232:235], v[148:151], v[164:167]
    s_waitcnt lgkmcnt(1)
    v_mfma_f32_16x16x32_bf16 v[168:171], v[232:235], v[152:155], v[168:171]
    s_waitcnt lgkmcnt(0)
    v_mfma_f32_16x16x32_bf16 v[172:175], v[232:235], v[156:159], v[172:175]
    buffer_load_dwordx4 v[232:235], v3, s[52:55], s76 offen offset:2048 sc1
    v_mfma_f32_16x16x32_bf16 v[16:19], v[236:239], v[32:35], 0
    v_mfma_f32_16x16x32_bf16 v[20:23], v[236:239], v[36:39], 0
    v_mfma_f32_16x16x32_bf16 v[24:27], v[236:239], v[40:43], 0
    v_mfma_f32_16x16x32_bf16 v[28:31], v[236:239], v[44:47], 0
    buffer_load_dwordx4 v[236:239], v3, s[52:55], s76 offen offset:3072 sc1
    v_mfma_f32_16x16x32_bf16 v[16:19], v[240:243], v[48:51], v[16:19]
    v_mfma_f32_16x16x32_bf16 v[20:23], v[240:243], v[52:55], v[20:23]
    v_mfma_f32_16x16x32_bf16 v[24:27], v[240:243], v[56:59], v[24:27]
    v_mfma_f32_16x16x32_bf16 v[28:31], v[240:243], v[60:63], v[28:31]
    s_add_u32 s76, s76, 4096
    buffer_load_dwordx4 v[240:243], v3, s[52:55], s76 offen offset:0 sc1
    s_waitcnt vmcnt(18)
    v_mfma_f32_16x16x32_bf16 v[16:19], v[244:247], v[64:67], v[16:19]
    v_mfma_f32_16x16x32_bf16 v[20:23], v[244:247], v[68:71], v[20:23]
    v_mfma_f32_16x16x32_bf16 v[24:27], v[244:247], v[72:75], v[24:27]
    v_mfma_f32_16x16x32_bf16 v[28:31], v[244:247], v[76:79], v[28:31]
    buffer_load_dwordx4 v[244:247], v3, s[52:55], s76 offen offset:1024 sc1
    v_cvt_pk_bf16_f32 v8, v160, v161
    v_cvt_pk_bf16_f32 v9, v162, v163
    v_cvt_pk_bf16_f32 v10, v164, v165
    v_cvt_pk_bf16_f32 v11, v166, v167
    v_cvt_pk_bf16_f32 v12, v168, v169
    v_cvt_pk_bf16_f32 v13, v170, v171
    v_cvt_pk_bf16_f32 v14, v172, v173
    v_cvt_pk_bf16_f32 v15, v174, v175
    buffer_store_dwordx4 v[8:11], v2, s[52:55], s77 offen sc1
    buffer_store_dwordx4 v[12:15], v2, s[52:55], s77 offen offset:1024 sc1
    s_waitcnt vmcnt(20)
    v_mfma_f32_16x16x32_bf16 v[16:19], v[248:251], v[80:83], v[16:19]
    v_mfma_f32_16x16x32_bf16 v[20:23], v[248:251], v[84:87], v[20:23]
    v_mfma_f32_16x16x32_bf16 v[24:27], v[248:251], v[88:91], v[24:27]
    v_mfma_f32_16x16x32_bf16 v[28:31], v[248:251], v[92:95], v[28:31]
    buffer_load_dwordx4 v[248:251], v3, s[52:55], s76 offen offset:2048 sc1
    s_waitcnt vmcnt(20)
    v_mfma_f32_16x16x32_bf16 v[16:19], v[176:179], v[96:99], v[16:19]
    v_mfma_f32_16x16x32_bf16 v[20:23], v[176:179], v[100:103], v[20:23]
    v_mfma_f32_16x16x32_bf16 v[24:27], v[176:179], v[104:107], v[24:27]
    v_mfma_f32_16x16x32_bf16 v[28:31], v[176:179], v[108:111], v[28:31]
    buffer_load_dwordx4 v[176:179], v3, s[52:55], s76 offen offset:3072 sc1
    s_waitcnt vmcnt(20)
    v_mfma_f32_16x16x32_bf16 v[16:19], v[180:183], v[112:115], v[16:19]
    v_mfma_f32_16x16x32_bf16 v[20:23], v[180:183], v[116:119], v[20:23]
    v_mfma_f32_16x16x32_bf16 v[24:27], v[180:183], v[120:123], v[24:27]
    v_mfma_f32_16x16x32_bf16 v[28:31], v[180:183], v[124:127], v[28:31]
    s_waitcnt vmcnt(19)
    v_mfma_f32_16x16x32_bf16 v[16:19], v[184:187], v[128:131], v[16:19]
    v_mfma_f32_16x16x32_bf16 v[20:23], v[184:187], v[132:135], v[20:23]
    v_mfma_f32_16x16x32_bf16 v[24:27], v[184:187], v[136:139], v[24:27]
    v_mfma_f32_16x16x32_bf16 v[28:31], v[184:187], v[140:143], v[28:31]
    s_waitcnt vmcnt(18)
    v_mfma_f32_16x16x32_bf16 v[16:19], v[188:191], v[144:147], v[16:19]
    v_mfma_f32_16x16x32_bf16 v[20:23], v[188:191], v[148:151], v[20:23]
    v_mfma_f32_16x16x32_bf16 v[24:27], v[188:191], v[152:155], v[24:27]
    v_mfma_f32_16x16x32_bf16 v[28:31], v[188:191], v[156:159], v[28:31]
    s_waitcnt vmcnt(17)
    v_mfma_f32_16x16x32_bf16 v[160:163], v[192:195], v[32:35], 0
    v_mfma_f32_16x16x32_bf16 v[164:167], v[192:195], v[36:39], 0
    v_mfma_f32_16x16x32_bf16 v[168:171], v[192:195], v[40:43], 0
    v_mfma_f32_16x16x32_bf16 v[172:175], v[192:195], v[44:47], 0
    s_waitcnt vmcnt(16)
    v_mfma_f32_16x16x32_bf16 v[160:163], v[196:199], v[48:51], v[160:163]
    v_mfma_f32_16x16x32_bf16 v[164:167], v[196:199], v[52:55], v[164:167]
    v_mfma_f32_16x16x32_bf16 v[168:171], v[196:199], v[56:59], v[168:171]
    v_mfma_f32_16x16x32_bf16 v[172:175], v[196:199], v[60:63], v[172:175]
    s_waitcnt vmcnt(15)
    v_mfma_f32_16x16x32_bf16 v[160:163], v[200:203], v[64:67], v[160:163]
    v_mfma_f32_16x16x32_bf16 v[164:167], v[200:203], v[68:71], v[164:167]
    v_mfma_f32_16x16x32_bf16 v[168:171], v[200:203], v[72:75], v[168:171]
    v_mfma_f32_16x16x32_bf16 v[172:175], v[200:203], v[76:79], v[172:175]
    v_cvt_pk_bf16_f32 v8, v16, v17
    v_cvt_pk_bf16_f32 v9, v18, v19
    v_cvt_pk_bf16_f32 v10, v20, v21
    v_cvt_pk_bf16_f32 v11, v22, v23
    v_cvt_pk_bf16_f32 v12, v24, v25
    v_cvt_pk_bf16_f32 v13, v26, v27
    v_cvt_pk_bf16_f32 v14, v28, v29
    v_cvt_pk_bf16_f32 v15, v30, v31
    buffer_store_dwordx4 v[8:11], v2, s[52:55], s78 offen sc1
    buffer_store_dwordx4 v[12:15], v2, s[52:55], s78 offen offset:1024 sc1
    s_waitcnt vmcnt(16)
    v_mfma_f32_16x16x32_bf16 v[160:163], v[204:207], v[80:83], v[160:163]
    v_mfma_f32_16x16x32_bf16 v[164:167], v[204:207], v[84:87], v[164:167]
    v_mfma_f32_16x16x32_bf16 v[168:171], v[204:207], v[88:91], v[168:171]
    v_mfma_f32_16x16x32_bf16 v[172:175], v[204:207], v[92:95], v[172:175]
    s_waitcnt vmcnt(15)
    v_mfma_f32_16x16x32_bf16 v[160:163], v[208:211], v[96:99], v[160:163]
    v_mfma_f32_16x16x32_bf16 v[164:167], v[208:211], v[100:103], v[164:167]
    v_mfma_f32_16x16x32_bf16 v[168:171], v[208:211], v[104:107], v[168:171]
    v_mfma_f32_16x16x32_bf16 v[172:175], v[208:211], v[108:111], v[172:175]
    s_waitcnt vmcnt(14)
    v_mfma_f32_16x16x32_bf16 v[160:163], v[212:215], v[112:115], v[160:163]
    v_mfma_f32_16x16x32_bf16 v[164:167], v[212:215], v[116:119], v[164:167]
    v_mfma_f32_16x16x32_bf16 v[168:171], v[212:215], v[120:123], v[168:171]
    v_mfma_f32_16x16x32_bf16 v[172:175], v[212:215], v[124:127], v[172:175]
    s_waitcnt vmcnt(13)
    v_mfma_f32_16x16x32_bf16 v[160:163], v[216:219], v[128:131], v[160:163]
    v_mfma_f32_16x16x32_bf16 v[164:167], v[216:219], v[132:135], v[164:167]
    v_mfma_f32_16x16x32_bf16 v[168:171], v[216:219], v[136:139], v[168:171]
    v_mfma_f32_16x16x32_bf16 v[172:175], v[216:219], v[140:143], v[172:175]
    s_waitcnt vmcnt(12)
    v_mfma_f32_16x16x32_bf16 v[160:163], v[220:223], v[144:147], v[160:163]
    v_mfma_f32_16x16x32_bf16 v[164:167], v[220:223], v[148:151], v[164:167]
    v_mfma_f32_16x16x32_bf16 v[168:171], v[220:223], v[152:155], v[168:171]
    v_mfma_f32_16x16x32_bf16 v[172:175], v[220:223], v[156:159], v[172:175]
    s_nop 4
    v_cvt_pk_bf16_f32 v8, v160, v161
    v_cvt_pk_bf16_f32 v9, v162, v163
    v_cvt_pk_bf16_f32 v10, v164, v165
    v_cvt_pk_bf16_f32 v11, v166, v167
    v_cvt_pk_bf16_f32 v12, v168, v169
    v_cvt_pk_bf16_f32 v13, v170, v171
    v_cvt_pk_bf16_f32 v14, v172, v173
    v_cvt_pk_bf16_f32 v15, v174, v175
    buffer_store_dwordx4 v[8:11], v2, s[52:55], s79 offen sc1
    buffer_store_dwordx4 v[12:15], v2, s[52:55], s79 offen offset:1024 sc1
    s_waitcnt vmcnt(0)
    s_barrier
    s_lshl_b32 s81, s64, 8
    s_add_u32 s81, s81, 10240
    v_mov_b32 v9, 0
    s_and_b32 s80, s3, 3
    s_lshl_b32 s82, s65, 2
    s_add_u32 s82, s82, s80
    s_lshl_b32 s83, s82, 6
    s_add_u32 s83, s83, 58112
    v_lshrrev_b32 v5, 4, v1
    v_lshlrev_b32 v10, 4, v5
    s_lshl_b32 s84, s80, 11
    s_add_u32 s84, s84, 0
    v_lshl_add_u32 v11, v1, 5, s84
    s_cmp_ge_u32 s3, 4
    s_cbranch_scc1 L_fin47
    s_cmp_lg_u32 s3, 0
    s_cbranch_scc1 L_g1
    v_mov_b32 v8, 1
    s_mov_b64 exec, 1
    buffer_atomic_add v8, v9, s[52:55], s81 offen sc1
    s_mov_b64 exec, -1
L_g1:
    buffer_load_dwordx4 v[12:15], v10, s[52:55], s83 offen sc1
    v_mfma_f32_16x16x32_bf16 v[16:19], v[224:227], v[32:35], 0
    v_mfma_f32_16x16x32_bf16 v[20:23], v[224:227], v[36:39], 0
    v_mfma_f32_16x16x32_bf16 v[24:27], v[224:227], v[40:43], 0
    v_mfma_f32_16x16x32_bf16 v[28:31], v[224:227], v[44:47], 0
    v_mfma_f32_16x16x32_bf16 v[16:19], v[228:231], v[48:51], v[16:19]
    v_mfma_f32_16x16x32_bf16 v[20:23], v[228:231], v[52:55], v[20:23]
    v_mfma_f32_16x16x32_bf16 v[24:27], v[228:231], v[56:59], v[24:27]
    v_mfma_f32_16x16x32_bf16 v[28:31], v[228:231], v[60:63], v[28:31]
    v_mfma_f32_16x16x32_bf16 v[16:19], v[232:235], v[64:67], v[16:19]
    v_mfma_f32_16x16x32_bf16 v[20:23], v[232:235], v[68:71], v[20:23]
    v_mfma_f32_16x16x32_bf16 v[24:27], v[232:235], v[72:75], v[24:27]
    v_mfma_f32_16x16x32_bf16 v[28:31], v[232:235], v[76:79], v[28:31]
    v_mfma_f32_16x16x32_bf16 v[16:19], v[236:239], v[80:83], v[16:19]
    v_mfma_f32_16x16x32_bf16 v[20:23], v[236:239], v[84:87], v[20:23]
    v_mfma_f32_16x16x32_bf16 v[24:27], v[236:239], v[88:91], v[24:27]
    v_mfma_f32_16x16x32_bf16 v[28:31], v[236:239], v[92:95], v[28:31]
    v_mfma_f32_16x16x32_bf16 v[16:19], v[240:243], v[96:99], v[16:19]
    v_mfma_f32_16x16x32_bf16 v[20:23], v[240:243], v[100:103], v[20:23]
    v_mfma_f32_16x16x32_bf16 v[24:27], v[240:243], v[104:107], v[24:27]
    v_mfma_f32_16x16x32_bf16 v[28:31], v[240:243], v[108:111], v[28:31]
    v_mfma_f32_16x16x32_bf16 v[16:19], v[244:247], v[112:115], v[16:19]
    v_mfma_f32_16x16x32_bf16 v[20:23], v[244:247], v[116:119], v[20:23]
    v_mfma_f32_16x16x32_bf16 v[24:27], v[244:247], v[120:123], v[24:27]
    v_mfma_f32_16x16x32_bf16 v[28:31], v[244:247], v[124:127], v[28:31]
    v_mfma_f32_16x16x32_bf16 v[16:19], v[248:251], v[128:131], v[16:19]
    v_mfma_f32_16x16x32_bf16 v[20:23], v[248:251], v[132:135], v[20:23]
    v_mfma_f32_16x16x32_bf16 v[24:27], v[248:251], v[136:139], v[24:27]
    v_mfma_f32_16x16x32_bf16 v[28:31], v[248:251], v[140:143], v[28:31]
    v_mfma_f32_16x16x32_bf16 v[16:19], v[176:179], v[144:147], v[16:19]
    v_mfma_f32_16x16x32_bf16 v[20:23], v[176:179], v[148:151], v[20:23]
    v_mfma_f32_16x16x32_bf16 v[24:27], v[176:179], v[152:155], v[24:27]
    v_mfma_f32_16x16x32_bf16 v[28:31], v[176:179], v[156:159], v[28:31]
    v_bfe_u32 v4, v1, 2, 2
    v_lshl_add_u32 v6, v5, 2, v4
    v_lshlrev_b32 v6, 7, v6
    v_and_b32 v4, 2, v4
    v_lshrrev_b32 v7, 1, v5
    v_or_b32 v4, v4, v7
    v_lshl_add_u32 v6, v4, 5, v6
    v_and_b32 v4, 3, v1
    v_lshl_add_u32 v6, v4, 3, v6
    s_lshr_b32 s85, s3, 2
    s_lshl_b32 s86, s85, 6
    v_xor_b32 v6, s86, v6
    s_lshl_b32 s84, s80, 11
    s_add_u32 s84, s84, 155648
    v_xor_b32 v7, 32, v6
    v_add_u32 v6, s84, v6
    v_add_u32 v7, s84, v7
    s_mul_i32 s84, s64, 7
    s_add_u32 s84, s84, s65
    s_mul_i32 s84, s84, 57344
    s_lshl_b32 s86, s80, 11
    s_add_u32 s84, s84, s86
    s_lshl_b32 s86, s85, 10
    s_add_u32 s84, s84, s86
    s_add_u32 s84, s84, 13893632
    s_add_u32 s72, s65, 1
    s_sub_u32 s86, s72, 7
    s_cmp_ge_u32 s72, 7
    s_cselect_b32 s72, s86, s72
    s_lshl_b32 s72, s72, 13
    s_add_u32 s72, s72, s84
    s_add_u32 s73, s65, 2
    s_sub_u32 s86, s73, 7
    s_cmp_ge_u32 s73, 7
    s_cselect_b32 s73, s86, s73
    s_lshl_b32 s73, s73, 13
    s_add_u32 s73, s73, s84
    s_add_u32 s74, s65, 3
    s_sub_u32 s86, s74, 7
    s_cmp_ge_u32 s74, 7
    s_cselect_b32 s74, s86, s74
    s_lshl_b32 s74, s74, 13
    s_add_u32 s74, s74, s84
    s_add_u32 s75, s65, 4
    s_sub_u32 s86, s75, 7
    s_cmp_ge_u32 s75, 7
    s_cselect_b32 s75, s86, s75
    s_lshl_b32 s75, s75, 13
    s_add_u32 s75, s75, s84
    s_add_u32 s76, s65, 5
    s_sub_u32 s86, s76, 7
    s_cmp_ge_u32 s76, 7
    s_cselect_b32 s76, s86, s76
    s_lshl_b32 s76, s76, 13
    s_add_u32 s76, s76, s84
    s_add_u32 s77, s65, 6
    s_sub_u32 s86, s77, 7
    s_cmp_ge_u32 s77, 7
    s_cselect_b32 s77, s86, s77
    s_lshl_b32 s77, s77, 13
    s_add_u32 s77, s77, s84
    v_and_b32 v4, 15, v1
    v_mul_u32_u24 v4, 896, v4
    v_lshl_add_u32 v4, v5, 3, v4
    s_lshl_b32 s86, s64, 1
    s_add_u32 s85, s85, s86
    s_mul_i32 s85, s85, 28672
    s_lshl_b32 s86, s82, 5
    s_add_u32 s85, s85, s86
    s_mov_b32 s56, s46
    s_mov_b32 s57, s47
    s_mov_b32 s58, 1835008
    ds_write_b128 v11, v[24:27]
    ds_write_b128 v11, v[28:31] offset:16
    s_waitcnt lgkmcnt(0)
    s_barrier
    s_branch L_fin
L_fin47:
    buffer_load_dwordx4 v[12:15], v10, s[52:55], s83 offen sc1
    v_bfe_u32 v4, v1, 2, 2
    v_lshl_add_u32 v6, v5, 2, v4
    v_lshlrev_b32 v6, 7, v6
    v_and_b32 v4, 2, v4
    v_lshrrev_b32 v7, 1, v5
    v_or_b32 v4, v4, v7
    v_lshl_add_u32 v6, v4, 5, v6
    v_and_b32 v4, 3, v1
    v_lshl_add_u32 v6, v4, 3, v6
    s_lshr_b32 s85, s3, 2
    s_lshl_b32 s86, s85, 6
    v_xor_b32 v6, s86, v6
    s_lshl_b32 s84, s80, 11
    s_add_u32 s84, s84, 155648
    v_xor_b32 v7, 32, v6
    v_add_u32 v6, s84, v6
    v_add_u32 v7, s84, v7
    s_mul_i32 s84, s64, 7
    s_add_u32 s84, s84, s65
    s_mul_i32 s84, s84, 57344
    s_lshl_b32 s86, s80, 11
    s_add_u32 s84, s84, s86
    s_lshl_b32 s86, s85, 10
    s_add_u32 s84, s84, s86
    s_add_u32 s84, s84, 13893632
    s_add_u32 s72, s65, 1
    s_sub_u32 s86, s72, 7
    s_cmp_ge_u32 s72, 7
    s_cselect_b32 s72, s86, s72
    s_lshl_b32 s72, s72, 13
    s_add_u32 s72, s72, s84
    s_add_u32 s73, s65, 2
    s_sub_u32 s86, s73, 7
    s_cmp_ge_u32 s73, 7
    s_cselect_b32 s73, s86, s73
    s_lshl_b32 s73, s73, 13
    s_add_u32 s73, s73, s84
    s_add_u32 s74, s65, 3
    s_sub_u32 s86, s74, 7
    s_cmp_ge_u32 s74, 7
    s_cselect_b32 s74, s86, s74
    s_lshl_b32 s74, s74, 13
    s_add_u32 s74, s74, s84
    s_add_u32 s75, s65, 4
    s_sub_u32 s86, s75, 7
    s_cmp_ge_u32 s75, 7
    s_cselect_b32 s75, s86, s75
    s_lshl_b32 s75, s75, 13
    s_add_u32 s75, s75, s84
    s_add_u32 s76, s65, 5
    s_sub_u32 s86, s76, 7
    s_cmp_ge_u32 s76, 7
    s_cselect_b32 s76, s86, s76
    s_lshl_b32 s76, s76, 13
    s_add_u32 s76, s76, s84
    s_add_u32 s77, s65, 6
    s_sub_u32 s86, s77, 7
    s_cmp_ge_u32 s77, 7
    s_cselect_b32 s77, s86, s77
    s_lshl_b32 s77, s77, 13
    s_add_u32 s77, s77, s84
    v_and_b32 v4, 15, v1
    v_mul_u32_u24 v4, 896, v4
    v_lshl_add_u32 v4, v5, 3, v4
    s_lshl_b32 s86, s64, 1
    s_add_u32 s85, s85, s86
    s_mul_i32 s85, s85, 28672
    s_lshl_b32 s86, s82, 5
    s_add_u32 s85, s85, s86
    s_mov_b32 s56, s46
    s_mov_b32 s57, s47
    s_mov_b32 s58, 1835008
    s_cmp_lg_u32 s3, 4
    s_cbranch_scc1 L_g2
    s_mov_b32 s87, 0
L_poll6:
    buffer_load_dword v8, v9, s[52:55], s81 offen sc1
    s_waitcnt vmcnt(0)
    v_cmp_ne_u32 vcc, 7, v8
    s_nop 4
    s_cbranch_vccz L_pdone6
    s_sleep 1
    s_add_u32 s87, s87, 1
    s_cmp_lt_u32 s87, 20000
    s_cbranch_scc1 L_poll6
L_pdone6:
L_g2:
    s_barrier
    ds_read_b128 v[16:19], v11
    ds_read_b128 v[20:23], v11 offset:16
L_fin:
    buffer_load_dwordx4 v[48:51], v2, s[52:55], s72 offen sc1
    buffer_load_dwordx4 v[52:55], v2, s[52:55], s73 offen sc1
    buffer_load_dwordx4 v[56:59], v2, s[52:55], s74 offen sc1
    buffer_load_dwordx4 v[60:63], v2, s[52:55], s75 offen sc1
    buffer_load_dwordx4 v[64:67], v2, s[52:55], s76 offen sc1
    buffer_load_dwordx4 v[68:71], v2, s[52:55], s77 offen sc1
    ds_read_b64_tr_b16 v[32:33], v6
    ds_read_b64_tr_b16 v[34:35], v7
    s_waitcnt vmcnt(6)
    v_xor_b32 v45, s60, v13
    v_xor_b32 v46, s60, v15
    v_or_b32 v45, v45, v46
    v_cmp_ne_u32 vcc, 0, v45
    s_nop 4
    s_cbranch_vccz L_gbok
    s_mov_b32 s87, 0
L_poll7:
    buffer_load_dwordx4 v[12:15], v10, s[52:55], s83 offen sc1
    s_waitcnt vmcnt(0)
    v_xor_b32 v45, s60, v13
    v_xor_b32 v46, s60, v15
    v_or_b32 v45, v45, v46
    v_cmp_ne_u32 vcc, 0, v45
    s_nop 4
    s_cbranch_vccz L_pdone7
    s_sleep 1
    s_add_u32 s87, s87, 1
    s_cmp_lt_u32 s87, 20000
    s_cbranch_scc1 L_poll7
L_pdone7:
L_gbok:
    v_lshlrev_b32 v96, 16, v12
    v_and_b32 v97, 0xffff0000, v12
    v_lshlrev_b32 v98, 16, v14
    v_and_b32 v99, 0xffff0000, v14
    s_waitcnt lgkmcnt(1)
    v_lshlrev_b32 v100, 16, v32
    v_and_b32 v101, 0xffff0000, v32
    v_lshlrev_b32 v102, 16, v33
    v_and_b32 v103, 0xffff0000, v33
    s_waitcnt lgkmcnt(0)
    v_lshlrev_b32 v104, 16, v34
    v_and_b32 v105, 0xffff0000, v34
    v_lshlrev_b32 v106, 16, v35
    v_and_b32 v107, 0xffff0000, v35
    s_waitcnt vmcnt(5)
    v_lshlrev_b32 v116, 16, v48
    v_and_b32 v117, 0xffff0000, v48
    v_pk_add_f32 v[16:17], v[16:17], v[116:117]
    v_lshlrev_b32 v118, 16, v49
    v_and_b32 v119, 0xffff0000, v49
    v_pk_add_f32 v[18:19], v[18:19], v[118:119]
    v_lshlrev_b32 v116, 16, v50
    v_and_b32 v117, 0xffff0000, v50
    v_pk_add_f32 v[20:21], v[20:21], v[116:117]
    v_lshlrev_b32 v118, 16, v51
    v_and_b32 v119, 0xffff0000, v51
    v_pk_add_f32 v[22:23], v[22:23], v[118:119]
    s_waitcnt vmcnt(4)
    v_lshlrev_b32 v116, 16, v52
    v_and_b32 v117, 0xffff0000, v52
    v_pk_add_f32 v[16:17], v[16:17], v[116:117]
    v_lshlrev_b32 v118, 16, v53
    v_and_b32 v119, 0xffff0000, v53
    v_pk_add_f32 v[18:19], v[18:19], v[118:119]
    v_lshlrev_b32 v116, 16, v54
    v_and_b32 v117, 0xffff0000, v54
    v_pk_add_f32 v[20:21], v[20:21], v[116:117]
    v_lshlrev_b32 v118, 16, v55
    v_and_b32 v119, 0xffff0000, v55
    v_pk_add_f32 v[22:23], v[22:23], v[118:119]
    s_waitcnt vmcnt(3)
    v_lshlrev_b32 v116, 16, v56
    v_and_b32 v117, 0xffff0000, v56
    v_pk_add_f32 v[16:17], v[16:17], v[116:117]
    v_lshlrev_b32 v118, 16, v57
    v_and_b32 v119, 0xffff0000, v57
    v_pk_add_f32 v[18:19], v[18:19], v[118:119]
    v_lshlrev_b32 v116, 16, v58
    v_and_b32 v117, 0xffff0000, v58
    v_pk_add_f32 v[20:21], v[20:21], v[116:117]
    v_lshlrev_b32 v118, 16, v59
    v_and_b32 v119, 0xffff0000, v59
    v_pk_add_f32 v[22:23], v[22:23], v[118:119]
    s_waitcnt vmcnt(2)
    v_lshlrev_b32 v116, 16, v60
    v_and_b32 v117, 0xffff0000, v60
    v_pk_add_f32 v[16:17], v[16:17], v[116:117]
    v_lshlrev_b32 v118, 16, v61
    v_and_b32 v119, 0xffff0000, v61
    v_pk_add_f32 v[18:19], v[18:19], v[118:119]
    v_lshlrev_b32 v116, 16, v62
    v_and_b32 v117, 0xffff0000, v62
    v_pk_add_f32 v[20:21], v[20:21], v[116:117]
    v_lshlrev_b32 v118, 16, v63
    v_and_b32 v119, 0xffff0000, v63
    v_pk_add_f32 v[22:23], v[22:23], v[118:119]
    s_waitcnt vmcnt(1)
    v_lshlrev_b32 v116, 16, v64
    v_and_b32 v117, 0xffff0000, v64
    v_pk_add_f32 v[16:17], v[16:17], v[116:117]
    v_lshlrev_b32 v118, 16, v65
    v_and_b32 v119, 0xffff0000, v65
    v_pk_add_f32 v[18:19], v[18:19], v[118:119]
    v_lshlrev_b32 v116, 16, v66
    v_and_b32 v117, 0xffff0000, v66
    v_pk_add_f32 v[20:21], v[20:21], v[116:117]
    v_lshlrev_b32 v118, 16, v67
    v_and_b32 v119, 0xffff0000, v67
    v_pk_add_f32 v[22:23], v[22:23], v[118:119]
    s_waitcnt vmcnt(0)
    v_lshlrev_b32 v116, 16, v68
    v_and_b32 v117, 0xffff0000, v68
    v_pk_add_f32 v[16:17], v[16:17], v[116:117]
    v_lshlrev_b32 v118, 16, v69
    v_and_b32 v119, 0xffff0000, v69
    v_pk_add_f32 v[18:19], v[18:19], v[118:119]
    v_lshlrev_b32 v116, 16, v70
    v_and_b32 v117, 0xffff0000, v70
    v_pk_add_f32 v[20:21], v[20:21], v[116:117]
    v_lshlrev_b32 v118, 16, v71
    v_and_b32 v119, 0xffff0000, v71
    v_pk_add_f32 v[22:23], v[22:23], v[118:119]
    v_pk_fma_f32 v[100:101], v[16:17], v[96:97], v[100:101]
    v_pk_fma_f32 v[102:103], v[18:19], v[98:99], v[102:103]
    v_pk_fma_f32 v[104:105], v[20:21], v[96:97], v[104:105]
    v_pk_fma_f32 v[106:107], v[22:23], v[98:99], v[106:107]
    v_cvt_pk_bf16_f32 v48, v100, v101
    v_cvt_pk_bf16_f32 v49, v102, v103
    buffer_store_dwordx2 v[48:49], v4, s[56:59], s85 offen
    s_add_u32 s85, s85, 14336
    v_cvt_pk_bf16_f32 v50, v104, v105
    v_cvt_pk_bf16_f32 v51, v106, v107
    buffer_store_dwordx2 v[50:51], v4, s[56:59], s85 offen
    s_endpgm
L_spare:
    s_sub_u32 s63, s2, 224
    s_mul_i32 s79, s3, 56
    v_min_u32 v8, 55, v1
    v_add_u32 v8, s79, v8
    v_lshlrev_b32 v8, 1, v8
    global_load_short_d16_hi v20, v8, s[42:43]
    v_lshrrev_b32 v13, 3, v1
    v_add_u32 v8, s79, v13
    v_mul_u32_u24 v12, 5376, v8
    v_and_b32 v8, 7, v1
    v_lshl_add_u32 v12, v8, 4, v12
    s_add_u32 s80, s63, 7
    s_cmp_lt_u32 s63, 28
    s_cselect_b32 s80, s80, s63
    s_cmp_lt_u32 s63, 21
    s_cselect_b32 s80, s63, s80
    s_sub_u32 s81, s63, 28
    s_sub_u32 s82, s63, 7
    s_cmp_lt_u32 s81, 7
    s_cselect_b32 s66, s82, s80
    s_lshl_b32 s80, s66, 7
    v_add_u32 v11, s80, v12
    global_load_dwordx4 v[64:67], v11, s[44:45] nt
    v_add_u32 v11, 43008, v11
    global_load_dwordx4 v[68:71], v11, s[44:45] nt
    v_add_u32 v11, 43008, v11
    global_load_dwordx4 v[72:75], v11, s[44:45] nt
    v_add_u32 v11, 43008, v11
    global_load_dwordx4 v[76:79], v11, s[44:45] nt
    v_add_u32 v11, 43008, v11
    s_mul_i32 s75, s3, 912
    s_add_u32 s75, s75, 120064
    v_add_u32 v37, s75, v2
    v_lshrrev_b32 v38, 2, v0
    v_and_b32 v39, 3, v0
    v_mul_u32_u24 v14, 1824, v39
    v_lshl_add_u32 v14, v38, 2, v14
    v_add_u32 v14, 120064, v14
    v_lshlrev_b32 v38, 14, v38
    v_lshl_add_u32 v38, v39, 4, v38
    s_cmp_ge_u32 s3, 6
    s_cselect_b32 s75, s54, 2097152
    v_add_u32 v39, s75, v38
    s_lshl_b32 s76, s2, 6
    s_add_u32 s76, s76, 10092544
    s_lshl_b32 s75, s72, 3
    s_add_u32 s75, s75, 32768
    s_waitcnt lgkmcnt(0)
    s_add_u32 s60, s60, 1
    s_mov_b32 exec_hi, 0x00ffffff
    s_waitcnt vmcnt(5)
    ds_write_b128 v37, v[4:7]
    s_mov_b32 exec_hi, -1
    v_dot2c_f32_bf16 v34, v4, v36
    v_dot2c_f32_bf16 v35, v4, v4
    v_dot2c_f32_bf16 v34, v5, v36
    v_dot2c_f32_bf16 v35, v5, v5
    v_dot2c_f32_bf16 v34, v6, v36
    v_dot2c_f32_bf16 v35, v6, v6
    v_dot2c_f32_bf16 v34, v7, v36
    v_dot2c_f32_bf16 v35, v7, v7
    v_mov_b32 v5, s60
    v_mov_b32 v7, s60
    v_mov_b32 v17, s60
    v_mov_b32 v19, s60
    s_waitcnt lgkmcnt(0)
    s_barrier
    ds_read_b32 v4, v14
    ds_read_b32 v6, v14 offset:912
    ds_read_b32 v16, v14 offset:512
    ds_read_b32 v18, v14 offset:1424
    s_waitcnt lgkmcnt(2)
    buffer_store_dwordx4 v[4:7], v38, s[52:55], s76 offen sc1
    s_waitcnt lgkmcnt(0)
    buffer_store_dwordx4 v[16:19], v39, s[52:55], s76 offen sc1
    v_add_f32_dpp v34, v34, v34 row_shr:1 row_mask:0xf bank_mask:0xf
    v_add_f32_dpp v35, v35, v35 row_shr:1 row_mask:0xf bank_mask:0xf
    s_nop 0
    v_add_f32_dpp v34, v34, v34 row_shr:2 row_mask:0xf bank_mask:0xf
    v_add_f32_dpp v35, v35, v35 row_shr:2 row_mask:0xf bank_mask:0xf
    s_nop 0
    v_add_f32_dpp v34, v34, v34 row_shr:4 row_mask:0xf bank_mask:0xf
    v_add_f32_dpp v35, v35, v35 row_shr:4 row_mask:0xf bank_mask:0xf
    s_nop 0
    v_add_f32_dpp v34, v34, v34 row_shr:8 row_mask:0xf bank_mask:0xf
    v_add_f32_dpp v35, v35, v35 row_shr:8 row_mask:0xf bank_mask:0xf
    s_nop 0
    v_add_f32_dpp v34, v34, v34 row_bcast:15 row_mask:0xa bank_mask:0xf
    v_add_f32_dpp v35, v35, v35 row_bcast:15 row_mask:0xa bank_mask:0xf
    s_nop 0
    v_add_f32_dpp v34, v34, v34 row_bcast:31 row_mask:0xc bank_mask:0xf
    v_add_f32_dpp v35, v35, v35 row_bcast:31 row_mask:0xc bank_mask:0xf
    v_mul_f32 v34, 0x3b124925, v34
    v_mul_f32 v35, 0x3b124925, v35
    v_fma_f32 v35, -v34, v34, v35
    v_max_f32 v35, 0, v35
    v_cvt_pk_bf16_f32 v35, v35, v35
    v_lshlrev_b32 v35, 16, v35
    v_add_f32 v35, 0x3727c5ac, v35
    v_cvt_pk_bf16_f32 v35, v35, v35
    v_lshlrev_b32 v35, 16, v35
    v_sqrt_f32 v35, v35
    v_mov_b32 v36, 0
    v_cvt_pk_bf16_f32 v34, v34, v35
    v_mov_b32 v35, s60
    s_mov_b32 exec_lo, 0
    s_mov_b32 exec_hi, 0x80000000
    buffer_store_dwordx2 v[34:35], v36, s[52:55], s75 offen sc1
    s_mov_b64 exec, -1
    global_load_dwordx4 v[80:83], v11, s[44:45] nt
    v_add_u32 v11, 43008, v11
    global_load_dwordx4 v[84:87], v11, s[44:45] nt
    v_add_u32 v11, 43008, v11
    global_load_dwordx4 v[88:91], v11, s[44:45] nt
    s_waitcnt vmcnt(10)
    v_mul_f32 v21, 0xbfb8aa3b, v20
    v_exp_f32 v21, v21
    s_nop 0
    v_add_f32 v21, 1.0, v21
    v_rcp_f32 v21, v21
    s_nop 0
    v_mul_f32 v21, v20, v21
    v_cvt_pk_bf16_f32 v21, v21, v21
    v_lshlrev_b32 v21, 16, v21
    s_lshl_b32 s80, s3, 8
    v_lshl_add_u32 v22, v1, 2, s80
    ds_write_b32 v22, v21
    v_lshl_add_u32 v22, v13, 2, s80
    ds_read_b32 v40, v22 offset:0
    ds_read_b32 v41, v22 offset:32
    ds_read_b32 v42, v22 offset:64
    ds_read_b32 v43, v22 offset:96
    ds_read_b32 v44, v22 offset:128
    ds_read_b32 v45, v22 offset:160
    ds_read_b32 v46, v22 offset:192
    v_mov_b32 v24, 0
    v_mov_b32 v25, 0
    v_mov_b32 v26, 0
    v_mov_b32 v27, 0
    v_mov_b32 v28, 0
    v_mov_b32 v29, 0
    v_mov_b32 v30, 0
    v_mov_b32 v31, 0
    s_waitcnt vmcnt(9)
    v_lshlrev_b32 v32, 16, v64
    v_and_b32 v33, 0xffff0000, v64
    s_waitcnt lgkmcnt(5)
    v_pk_fma_f32 v[24:25], v[32:33], v[40:41], v[24:25] op_sel:[0,0,0] op_sel_hi:[1,0,1]
    v_lshlrev_b32 v34, 16, v65
    v_and_b32 v35, 0xffff0000, v65
    v_pk_fma_f32 v[26:27], v[34:35], v[40:41], v[26:27] op_sel:[0,0,0] op_sel_hi:[1,0,1]
    v_lshlrev_b32 v32, 16, v66
    v_and_b32 v33, 0xffff0000, v66
    v_pk_fma_f32 v[28:29], v[32:33], v[40:41], v[28:29] op_sel:[0,0,0] op_sel_hi:[1,0,1]
    v_lshlrev_b32 v34, 16, v67
    v_and_b32 v35, 0xffff0000, v67
    v_pk_fma_f32 v[30:31], v[34:35], v[40:41], v[30:31] op_sel:[0,0,0] op_sel_hi:[1,0,1]
    s_waitcnt vmcnt(8)
    v_lshlrev_b32 v32, 16, v68
    v_and_b32 v33, 0xffff0000, v68
    v_pk_fma_f32 v[24:25], v[32:33], v[40:41], v[24:25] op_sel:[0,1,0] op_sel_hi:[1,1,1]
    v_lshlrev_b32 v34, 16, v69
    v_and_b32 v35, 0xffff0000, v69
    v_pk_fma_f32 v[26:27], v[34:35], v[40:41], v[26:27] op_sel:[0,1,0] op_sel_hi:[1,1,1]
    v_lshlrev_b32 v32, 16, v70
    v_and_b32 v33, 0xffff0000, v70
    v_pk_fma_f32 v[28:29], v[32:33], v[40:41], v[28:29] op_sel:[0,1,0] op_sel_hi:[1,1,1]
    v_lshlrev_b32 v34, 16, v71
    v_and_b32 v35, 0xffff0000, v71
    v_pk_fma_f32 v[30:31], v[34:35], v[40:41], v[30:31] op_sel:[0,1,0] op_sel_hi:[1,1,1]
    s_waitcnt vmcnt(7)
    v_lshlrev_b32 v32, 16, v72
    v_and_b32 v33, 0xffff0000, v72
    s_waitcnt lgkmcnt(3)
    v_pk_fma_f32 v[24:25], v[32:33], v[42:43], v[24:25] op_sel:[0,0,0] op_sel_hi:[1,0,1]
    v_lshlrev_b32 v34, 16, v73
    v_and_b32 v35, 0xffff0000, v73
    v_pk_fma_f32 v[26:27], v[34:35], v[42:43], v[26:27] op_sel:[0,0,0] op_sel_hi:[1,0,1]
    v_lshlrev_b32 v32, 16, v74
    v_and_b32 v33, 0xffff0000, v74
    v_pk_fma_f32 v[28:29], v[32:33], v[42:43], v[28:29] op_sel:[0,0,0] op_sel_hi:[1,0,1]
    v_lshlrev_b32 v34, 16, v75
    v_and_b32 v35, 0xffff0000, v75
    v_pk_fma_f32 v[30:31], v[34:35], v[42:43], v[30:31] op_sel:[0,0,0] op_sel_hi:[1,0,1]
    s_waitcnt vmcnt(6)
    v_lshlrev_b32 v32, 16, v76
    v_and_b32 v33, 0xffff0000, v76
    v_pk_fma_f32 v[24:25], v[32:33], v[42:43], v[24:25] op_sel:[0,1,0] op_sel_hi:[1,1,1]
    v_lshlrev_b32 v34, 16, v77
    v_and_b32 v35, 0xffff0000, v77
    v_pk_fma_f32 v[26:27], v[34:35], v[42:43], v[26:27] op_sel:[0,1,0] op_sel_hi:[1,1,1]
    v_lshlrev_b32 v32, 16, v78
    v_and_b32 v33, 0xffff0000, v78
    v_pk_fma_f32 v[28:29], v[32:33], v[42:43], v[28:29] op_sel:[0,1,0] op_sel_hi:[1,1,1]
    v_lshlrev_b32 v34, 16, v79
    v_and_b32 v35, 0xffff0000, v79
    v_pk_fma_f32 v[30:31], v[34:35], v[42:43], v[30:31] op_sel:[0,1,0] op_sel_hi:[1,1,1]
    s_waitcnt vmcnt(2)
    v_lshlrev_b32 v32, 16, v80
    v_and_b32 v33, 0xffff0000, v80
    s_waitcnt lgkmcnt(1)
    v_pk_fma_f32 v[24:25], v[32:33], v[44:45], v[24:25] op_sel:[0,0,0] op_sel_hi:[1,0,1]
    v_lshlrev_b32 v34, 16, v81
    v_and_b32 v35, 0xffff0000, v81
    v_pk_fma_f32 v[26:27], v[34:35], v[44:45], v[26:27] op_sel:[0,0,0] op_sel_hi:[1,0,1]
    v_lshlrev_b32 v32, 16, v82
    v_and_b32 v33, 0xffff0000, v82
    v_pk_fma_f32 v[28:29], v[32:33], v[44:45], v[28:29] op_sel:[0,0,0] op_sel_hi:[1,0,1]
    v_lshlrev_b32 v34, 16, v83
    v_and_b32 v35, 0xffff0000, v83
    v_pk_fma_f32 v[30:31], v[34:35], v[44:45], v[30:31] op_sel:[0,0,0] op_sel_hi:[1,0,1]
    s_waitcnt vmcnt(1)
    v_lshlrev_b32 v32, 16, v84
    v_and_b32 v33, 0xffff0000, v84
    v_pk_fma_f32 v[24:25], v[32:33], v[44:45], v[24:25] op_sel:[0,1,0] op_sel_hi:[1,1,1]
    v_lshlrev_b32 v34, 16, v85
    v_and_b32 v35, 0xffff0000, v85
    v_pk_fma_f32 v[26:27], v[34:35], v[44:45], v[26:27] op_sel:[0,1,0] op_sel_hi:[1,1,1]
    v_lshlrev_b32 v32, 16, v86
    v_and_b32 v33, 0xffff0000, v86
    v_pk_fma_f32 v[28:29], v[32:33], v[44:45], v[28:29] op_sel:[0,1,0] op_sel_hi:[1,1,1]
    v_lshlrev_b32 v34, 16, v87
    v_and_b32 v35, 0xffff0000, v87
    v_pk_fma_f32 v[30:31], v[34:35], v[44:45], v[30:31] op_sel:[0,1,0] op_sel_hi:[1,1,1]
    s_waitcnt vmcnt(0)
    v_lshlrev_b32 v32, 16, v88
    v_and_b32 v33, 0xffff0000, v88
    s_waitcnt lgkmcnt(0)
    v_pk_fma_f32 v[24:25], v[32:33], v[46:47], v[24:25] op_sel:[0,0,0] op_sel_hi:[1,0,1]
    v_lshlrev_b32 v34, 16, v89
    v_and_b32 v35, 0xffff0000, v89
    v_pk_fma_f32 v[26:27], v[34:35], v[46:47], v[26:27] op_sel:[0,0,0] op_sel_hi:[1,0,1]
    v_lshlrev_b32 v32, 16, v90
    v_and_b32 v33, 0xffff0000, v90
    v_pk_fma_f32 v[28:29], v[32:33], v[46:47], v[28:29] op_sel:[0,0,0] op_sel_hi:[1,0,1]
    v_lshlrev_b32 v34, 16, v91
    v_and_b32 v35, 0xffff0000, v91
    v_pk_fma_f32 v[30:31], v[34:35], v[46:47], v[30:31] op_sel:[0,0,0] op_sel_hi:[1,0,1]
    s_min_u32 s70, s63, 27
    s_mov_b32 s56, s40
    s_mov_b32 s57, s41
    s_mov_b32 s58, 1605632
    s_mul_i32 s80, s70, 57344
    s_mul_i32 s81, s3, 7168
    s_add_u32 s80, s80, s81
    s_add_u32 m0, s81, 16384
    s_nop 0
    buffer_load_dwordx4 v2, s[56:59], s80 offen offset:0 nt lds
    buffer_load_dwordx4 v2, s[56:59], s80 offen offset:1024 nt lds
    buffer_load_dwordx4 v2, s[56:59], s80 offen offset:2048 nt lds
    buffer_load_dwordx4 v2, s[56:59], s80 offen offset:3072 nt lds
    s_add_u32 m0, s81, 20480
    s_add_u32 s80, s80, 4096
    buffer_load_dwordx4 v2, s[56:59], s80 offen offset:0 nt lds
    buffer_load_dwordx4 v2, s[56:59], s80 offen offset:1024 nt lds
    buffer_load_dwordx4 v2, s[56:59], s80 offen offset:2048 nt lds
    v_add_f32_dpp v24, v24, v24 row_ror:8 row_mask:0xf bank_mask:0xf
    v_add_f32_dpp v25, v25, v25 row_ror:8 row_mask:0xf bank_mask:0xf
    v_add_f32_dpp v26, v26, v26 row_ror:8 row_mask:0xf bank_mask:0xf
    v_add_f32_dpp v27, v27, v27 row_ror:8 row_mask:0xf bank_mask:0xf
    v_add_f32_dpp v28, v28, v28 row_ror:8 row_mask:0xf bank_mask:0xf
    v_add_f32_dpp v29, v29, v29 row_ror:8 row_mask:0xf bank_mask:0xf
    v_add_f32_dpp v30, v30, v30 row_ror:8 row_mask:0xf bank_mask:0xf
    v_add_f32_dpp v31, v31, v31 row_ror:8 row_mask:0xf bank_mask:0xf
    v_mov_b32 v32, v24
    v_mov_b32 v33, v25
    v_mov_b32 v34, v26
    v_mov_b32 v35, v27
    v_mov_b32 v36, v28
    v_mov_b32 v37, v29
    v_mov_b32 v38, v30
    v_mov_b32 v39, v31
    v_permlane16_swap_b32 v24, v32
    v_permlane16_swap_b32 v25, v33
    v_permlane16_swap_b32 v26, v34
    v_permlane16_swap_b32 v27, v35
    v_permlane16_swap_b32 v28, v36
    v_permlane16_swap_b32 v29, v37
    v_permlane16_swap_b32 v30, v38
    v_permlane16_swap_b32 v31, v39
    v_pk_add_f32 v[24:25], v[24:25], v[32:33]
    v_pk_add_f32 v[26:27], v[26:27], v[34:35]
    v_pk_add_f32 v[28:29], v[28:29], v[36:37]
    v_pk_add_f32 v[30:31], v[30:31], v[38:39]
    v_mov_b32 v32, v24
    v_mov_b32 v33, v25
    v_mov_b32 v34, v26
    v_mov_b32 v35, v27
    v_mov_b32 v36, v28
    v_mov_b32 v37, v29
    v_mov_b32 v38, v30
    v_mov_b32 v39, v31
    v_permlane32_swap_b32 v24, v32
    v_permlane32_swap_b32 v25, v33
    v_permlane32_swap_b32 v26, v34
    v_permlane32_swap_b32 v27, v35
    v_permlane32_swap_b32 v28, v36
    v_permlane32_swap_b32 v29, v37
    v_permlane32_swap_b32 v30, v38
    v_permlane32_swap_b32 v31, v39
    v_pk_add_f32 v[24:25], v[24:25], v[32:33]
    v_pk_add_f32 v[26:27], v[26:27], v[34:35]
    v_pk_add_f32 v[28:29], v[28:29], v[36:37]
    v_pk_add_f32 v[30:31], v[30:31], v[38:39]
    s_lshl_b32 s80, s3, 8
    s_add_u32 s80, s80, 4096
    v_lshl_add_u32 v32, v1, 5, s80
    s_mov_b64 exec, 0xff
    ds_write_b128 v32, v[24:27]
    ds_write_b128 v32, v[28:31] offset:16
    s_mov_b64 exec, -1
    v_lshlrev_b32 v32, 3, v1
    s_waitcnt lgkmcnt(0)
    s_barrier
    s_cmp_lg_u32 s3, 0
    s_cbranch_scc1 L_gv0
    s_mov_b32 exec_hi, 0
    ds_read_b64 v[48:49], v32 offset:4096
    ds_read_b64 v[50:51], v32 offset:4352
    ds_read_b64 v[52:53], v32 offset:4608
    ds_read_b64 v[54:55], v32 offset:4864
    ds_read_b64 v[56:57], v32 offset:5120
    ds_read_b64 v[58:59], v32 offset:5376
    ds_read_b64 v[60:61], v32 offset:5632
    ds_read_b64 v[62:63], v32 offset:5888
    s_mul_i32 s80, s66, 9363
    s_lshr_b32 s80, s80, 16
    s_cmp_eq_u32 s80, 1
    s_cselect_b32 s81, 1.0, 0
    s_cmp_eq_u32 s80, 4
    s_cselect_b32 s81, 1.0, s81
    s_waitcnt lgkmcnt(6)
    v_pk_add_f32 v[48:49], v[48:49], v[50:51]
    s_waitcnt lgkmcnt(5)
    v_pk_add_f32 v[48:49], v[48:49], v[52:53]
    s_waitcnt lgkmcnt(4)
    v_pk_add_f32 v[48:49], v[48:49], v[54:55]
    s_waitcnt lgkmcnt(3)
    v_pk_add_f32 v[48:49], v[48:49], v[56:57]
    s_waitcnt lgkmcnt(2)
    v_pk_add_f32 v[48:49], v[48:49], v[58:59]
    s_waitcnt lgkmcnt(1)
    v_pk_add_f32 v[48:49], v[48:49], v[60:61]
    s_waitcnt lgkmcnt(0)
    v_pk_add_f32 v[48:49], v[48:49], v[62:63]
    v_cvt_pk_bf16_f32 v48, v48, v49
    v_and_b32 v49, 0xffff0000, v48
    v_lshlrev_b32 v48, 16, v48
    v_add_f32 v48, s81, v48
    v_add_f32 v49, s81, v49
    v_cvt_pk_bf16_f32 v48, v48, v49
    v_mov_b32 v49, s60
    s_lshl_b32 s80, s66, 8
    s_add_u32 s80, s80, 49152
    buffer_store_dwordx2 v[48:49], v32, s[52:55], s80 offen sc1
    s_mov_b64 exec, -1
L_gv0:
    s_cmp_lt_u32 s63, 28
    s_cbranch_scc1 L_spw
    s_add_u32 s79, s63, 4
    s_add_u32 s80, s79, 7
    s_cmp_lt_u32 s79, 28
    s_cselect_b32 s80, s80, s79
    s_cmp_lt_u32 s79, 21
    s_cselect_b32 s80, s79, s80
    s_sub_u32 s81, s79, 28
    s_sub_u32 s82, s79, 7
    s_cmp_lt_u32 s81, 7
    s_cselect_b32 s66, s82, s80
    s_lshl_b32 s80, s66, 7
    v_add_u32 v11, s80, v12
    global_load_dwordx4 v[64:67], v11, s[44:45] nt
    v_add_u32 v11, 43008, v11
    global_load_dwordx4 v[68:71], v11, s[44:45] nt
    v_add_u32 v11, 43008, v11
    global_load_dwordx4 v[72:75], v11, s[44:45] nt
    v_add_u32 v11, 43008, v11
    global_load_dwordx4 v[76:79], v11, s[44:45] nt
    v_add_u32 v11, 43008, v11
    global_load_dwordx4 v[80:83], v11, s[44:45] nt
    v_add_u32 v11, 43008, v11
    global_load_dwordx4 v[84:87], v11, s[44:45] nt
    v_add_u32 v11, 43008, v11
    global_load_dwordx4 v[88:91], v11, s[44:45] nt
    v_mov_b32 v24, 0
    v_mov_b32 v25, 0
    v_mov_b32 v26, 0
    v_mov_b32 v27, 0
    v_mov_b32 v28, 0
    v_mov_b32 v29, 0
    v_mov_b32 v30, 0
    v_mov_b32 v31, 0
    s_waitcnt vmcnt(6)
    v_lshlrev_b32 v32, 16, v64
    v_and_b32 v33, 0xffff0000, v64
    v_pk_fma_f32 v[24:25], v[32:33], v[40:41], v[24:25] op_sel:[0,0,0] op_sel_hi:[1,0,1]
    v_lshlrev_b32 v34, 16, v65
    v_and_b32 v35, 0xffff0000, v65
    v_pk_fma_f32 v[26:27], v[34:35], v[40:41], v[26:27] op_sel:[0,0,0] op_sel_hi:[1,0,1]
    v_lshlrev_b32 v32, 16, v66
    v_and_b32 v33, 0xffff0000, v66
    v_pk_fma_f32 v[28:29], v[32:33], v[40:41], v[28:29] op_sel:[0,0,0] op_sel_hi:[1,0,1]
    v_lshlrev_b32 v34, 16, v67
    v_and_b32 v35, 0xffff0000, v67
    v_pk_fma_f32 v[30:31], v[34:35], v[40:41], v[30:31] op_sel:[0,0,0] op_sel_hi:[1,0,1]
    s_waitcnt vmcnt(5)
    v_lshlrev_b32 v32, 16, v68
    v_and_b32 v33, 0xffff0000, v68
    v_pk_fma_f32 v[24:25], v[32:33], v[40:41], v[24:25] op_sel:[0,1,0] op_sel_hi:[1,1,1]
    v_lshlrev_b32 v34, 16, v69
    v_and_b32 v35, 0xffff0000, v69
    v_pk_fma_f32 v[26:27], v[34:35], v[40:41], v[26:27] op_sel:[0,1,0] op_sel_hi:[1,1,1]
    v_lshlrev_b32 v32, 16, v70
    v_and_b32 v33, 0xffff0000, v70
    v_pk_fma_f32 v[28:29], v[32:33], v[40:41], v[28:29] op_sel:[0,1,0] op_sel_hi:[1,1,1]
    v_lshlrev_b32 v34, 16, v71
    v_and_b32 v35, 0xffff0000, v71
    v_pk_fma_f32 v[30:31], v[34:35], v[40:41], v[30:31] op_sel:[0,1,0] op_sel_hi:[1,1,1]
    s_waitcnt vmcnt(4)
    v_lshlrev_b32 v32, 16, v72
    v_and_b32 v33, 0xffff0000, v72
    v_pk_fma_f32 v[24:25], v[32:33], v[42:43], v[24:25] op_sel:[0,0,0] op_sel_hi:[1,0,1]
    v_lshlrev_b32 v34, 16, v73
    v_and_b32 v35, 0xffff0000, v73
    v_pk_fma_f32 v[26:27], v[34:35], v[42:43], v[26:27] op_sel:[0,0,0] op_sel_hi:[1,0,1]
    v_lshlrev_b32 v32, 16, v74
    v_and_b32 v33, 0xffff0000, v74
    v_pk_fma_f32 v[28:29], v[32:33], v[42:43], v[28:29] op_sel:[0,0,0] op_sel_hi:[1,0,1]
    v_lshlrev_b32 v34, 16, v75
    v_and_b32 v35, 0xffff0000, v75
    v_pk_fma_f32 v[30:31], v[34:35], v[42:43], v[30:31] op_sel:[0,0,0] op_sel_hi:[1,0,1]
    s_waitcnt vmcnt(3)
    v_lshlrev_b32 v32, 16, v76
    v_and_b32 v33, 0xffff0000, v76
    v_pk_fma_f32 v[24:25], v[32:33], v[42:43], v[24:25] op_sel:[0,1,0] op_sel_hi:[1,1,1]
    v_lshlrev_b32 v34, 16, v77
    v_and_b32 v35, 0xffff0000, v77
    v_pk_fma_f32 v[26:27], v[34:35], v[42:43], v[26:27] op_sel:[0,1,0] op_sel_hi:[1,1,1]
    v_lshlrev_b32 v32, 16, v78
    v_and_b32 v33, 0xffff0000, v78
    v_pk_fma_f32 v[28:29], v[32:33], v[42:43], v[28:29] op_sel:[0,1,0] op_sel_hi:[1,1,1]
    v_lshlrev_b32 v34, 16, v79
    v_and_b32 v35, 0xffff0000, v79
    v_pk_fma_f32 v[30:31], v[34:35], v[42:43], v[30:31] op_sel:[0,1,0] op_sel_hi:[1,1,1]
    s_waitcnt vmcnt(2)
    v_lshlrev_b32 v32, 16, v80
    v_and_b32 v33, 0xffff0000, v80
    v_pk_fma_f32 v[24:25], v[32:33], v[44:45], v[24:25] op_sel:[0,0,0] op_sel_hi:[1,0,1]
    v_lshlrev_b32 v34, 16, v81
    v_and_b32 v35, 0xffff0000, v81
    v_pk_fma_f32 v[26:27], v[34:35], v[44:45], v[26:27] op_sel:[0,0,0] op_sel_hi:[1,0,1]
    v_lshlrev_b32 v32, 16, v82
    v_and_b32 v33, 0xffff0000, v82
    v_pk_fma_f32 v[28:29], v[32:33], v[44:45], v[28:29] op_sel:[0,0,0] op_sel_hi:[1,0,1]
    v_lshlrev_b32 v34, 16, v83
    v_and_b32 v35, 0xffff0000, v83
    v_pk_fma_f32 v[30:31], v[34:35], v[44:45], v[30:31] op_sel:[0,0,0] op_sel_hi:[1,0,1]
    s_waitcnt vmcnt(1)
    v_lshlrev_b32 v32, 16, v84
    v_and_b32 v33, 0xffff0000, v84
    v_pk_fma_f32 v[24:25], v[32:33], v[44:45], v[24:25] op_sel:[0,1,0] op_sel_hi:[1,1,1]
    v_lshlrev_b32 v34, 16, v85
    v_and_b32 v35, 0xffff0000, v85
    v_pk_fma_f32 v[26:27], v[34:35], v[44:45], v[26:27] op_sel:[0,1,0] op_sel_hi:[1,1,1]
    v_lshlrev_b32 v32, 16, v86
    v_and_b32 v33, 0xffff0000, v86
    v_pk_fma_f32 v[28:29], v[32:33], v[44:45], v[28:29] op_sel:[0,1,0] op_sel_hi:[1,1,1]
    v_lshlrev_b32 v34, 16, v87
    v_and_b32 v35, 0xffff0000, v87
    v_pk_fma_f32 v[30:31], v[34:35], v[44:45], v[30:31] op_sel:[0,1,0] op_sel_hi:[1,1,1]
    s_waitcnt vmcnt(0)
    v_lshlrev_b32 v32, 16, v88
    v_and_b32 v33, 0xffff0000, v88
    v_pk_fma_f32 v[24:25], v[32:33], v[46:47], v[24:25] op_sel:[0,0,0] op_sel_hi:[1,0,1]
    v_lshlrev_b32 v34, 16, v89
    v_and_b32 v35, 0xffff0000, v89
    v_pk_fma_f32 v[26:27], v[34:35], v[46:47], v[26:27] op_sel:[0,0,0] op_sel_hi:[1,0,1]
    v_lshlrev_b32 v32, 16, v90
    v_and_b32 v33, 0xffff0000, v90
    v_pk_fma_f32 v[28:29], v[32:33], v[46:47], v[28:29] op_sel:[0,0,0] op_sel_hi:[1,0,1]
    v_lshlrev_b32 v34, 16, v91
    v_and_b32 v35, 0xffff0000, v91
    v_pk_fma_f32 v[30:31], v[34:35], v[46:47], v[30:31] op_sel:[0,0,0] op_sel_hi:[1,0,1]
    v_add_f32_dpp v24, v24, v24 row_ror:8 row_mask:0xf bank_mask:0xf
    v_add_f32_dpp v25, v25, v25 row_ror:8 row_mask:0xf bank_mask:0xf
    v_add_f32_dpp v26, v26, v26 row_ror:8 row_mask:0xf bank_mask:0xf
    v_add_f32_dpp v27, v27, v27 row_ror:8 row_mask:0xf bank_mask:0xf
    v_add_f32_dpp v28, v28, v28 row_ror:8 row_mask:0xf bank_mask:0xf
    v_add_f32_dpp v29, v29, v29 row_ror:8 row_mask:0xf bank_mask:0xf
    v_add_f32_dpp v30, v30, v30 row_ror:8 row_mask:0xf bank_mask:0xf
    v_add_f32_dpp v31, v31, v31 row_ror:8 row_mask:0xf bank_mask:0xf
    v_mov_b32 v32, v24
    v_mov_b32 v33, v25
    v_mov_b32 v34, v26
    v_mov_b32 v35, v27
    v_mov_b32 v36, v28
    v_mov_b32 v37, v29
    v_mov_b32 v38, v30
    v_mov_b32 v39, v31
    v_permlane16_swap_b32 v24, v32
    v_permlane16_swap_b32 v25, v33
    v_permlane16_swap_b32 v26, v34
    v_permlane16_swap_b32 v27, v35
    v_permlane16_swap_b32 v28, v36
    v_permlane16_swap_b32 v29, v37
    v_permlane16_swap_b32 v30, v38
    v_permlane16_swap_b32 v31, v39
    v_pk_add_f32 v[24:25], v[24:25], v[32:33]
    v_pk_add_f32 v[26:27], v[26:27], v[34:35]
    v_pk_add_f32 v[28:29], v[28:29], v[36:37]
    v_pk_add_f32 v[30:31], v[30:31], v[38:39]
    v_mov_b32 v32, v24
    v_mov_b32 v33, v25
    v_mov_b32 v34, v26
    v_mov_b32 v35, v27
    v_mov_b32 v36, v28
    v_mov_b32 v37, v29
    v_mov_b32 v38, v30
    v_mov_b32 v39, v31
    v_permlane32_swap_b32 v24, v32
    v_permlane32_swap_b32 v25, v33
    v_permlane32_swap_b32 v26, v34
    v_permlane32_swap_b32 v27, v35
    v_permlane32_swap_b32 v28, v36
    v_permlane32_swap_b32 v29, v37
    v_permlane32_swap_b32 v30, v38
    v_permlane32_swap_b32 v31, v39
    v_pk_add_f32 v[24:25], v[24:25], v[32:33]
    v_pk_add_f32 v[26:27], v[26:27], v[34:35]
    v_pk_add_f32 v[28:29], v[28:29], v[36:37]
    v_pk_add_f32 v[30:31], v[30:31], v[38:39]
    s_lshl_b32 s80, s3, 8
    s_add_u32 s80, s80, 6144
    v_lshl_add_u32 v32, v1, 5, s80
    s_mov_b64 exec, 0xff
    ds_write_b128 v32, v[24:27]
    ds_write_b128 v32, v[28:31] offset:16
    s_mov_b64 exec, -1
    v_lshlrev_b32 v32, 3, v1
    s_waitcnt lgkmcnt(0)
    s_barrier
    s_cmp_lg_u32 s3, 0
    s_cbranch_scc1 L_gv1
    s_mov_b32 exec_hi, 0
    ds_read_b64 v[48:49], v32 offset:6144
    ds_read_b64 v[50:51], v32 offset:6400
    ds_read_b64 v[52:53], v32 offset:6656
    ds_read_b64 v[54:55], v32 offset:6912
    ds_read_b64 v[56:57], v32 offset:7168
    ds_read_b64 v[58:59], v32 offset:7424
    ds_read_b64 v[60:61], v32 offset:7680
    ds_read_b64 v[62:63], v32 offset:7936
    s_mul_i32 s80, s66, 9363
    s_lshr_b32 s80, s80, 16
    s_cmp_eq_u32 s80, 1
    s_cselect_b32 s81, 1.0, 0
    s_cmp_eq_u32 s80, 4
    s_cselect_b32 s81, 1.0, s81
    s_waitcnt lgkmcnt(6)
    v_pk_add_f32 v[48:49], v[48:49], v[50:51]
    s_waitcnt lgkmcnt(5)
    v_pk_add_f32 v[48:49], v[48:49], v[52:53]
    s_waitcnt lgkmcnt(4)
    v_pk_add_f32 v[48:49], v[48:49], v[54:55]
    s_waitcnt lgkmcnt(3)
    v_pk_add_f32 v[48:49], v[48:49], v[56:57]
    s_waitcnt lgkmcnt(2)
    v_pk_add_f32 v[48:49], v[48:49], v[58:59]
    s_waitcnt lgkmcnt(1)
    v_pk_add_f32 v[48:49], v[48:49], v[60:61]
    s_waitcnt lgkmcnt(0)
    v_pk_add_f32 v[48:49], v[48:49], v[62:63]
    v_cvt_pk_bf16_f32 v48, v48, v49
    v_and_b32 v49, 0xffff0000, v48
    v_lshlrev_b32 v48, 16, v48
    v_add_f32 v48, s81, v48
    v_add_f32 v49, s81, v49
    v_cvt_pk_bf16_f32 v48, v48, v49
    v_mov_b32 v49, s60
    s_lshl_b32 s80, s66, 8
    s_add_u32 s80, s80, 49152
    buffer_store_dwordx2 v[48:49], v32, s[52:55], s80 offen sc1
    s_mov_b64 exec, -1
L_gv1:
    s_add_u32 s79, s63, 8
    s_add_u32 s80, s79, 7
    s_cmp_lt_u32 s79, 28
    s_cselect_b32 s80, s80, s79
    s_cmp_lt_u32 s79, 21
    s_cselect_b32 s80, s79, s80
    s_sub_u32 s81, s79, 28
    s_sub_u32 s82, s79, 7
    s_cmp_lt_u32 s81, 7
    s_cselect_b32 s66, s82, s80
    s_lshl_b32 s80, s66, 7
    v_add_u32 v11, s80, v12
    global_load_dwordx4 v[64:67], v11, s[44:45] nt
    v_add_u32 v11, 43008, v11
    global_load_dwordx4 v[68:71], v11, s[44:45] nt
    v_add_u32 v11, 43008, v11
    global_load_dwordx4 v[72:75], v11, s[44:45] nt
    v_add_u32 v11, 43008, v11
    global_load_dwordx4 v[76:79], v11, s[44:45] nt
    v_add_u32 v11, 43008, v11
    global_load_dwordx4 v[80:83], v11, s[44:45] nt
    v_add_u32 v11, 43008, v11
    global_load_dwordx4 v[84:87], v11, s[44:45] nt
    v_add_u32 v11, 43008, v11
    global_load_dwordx4 v[88:91], v11, s[44:45] nt
    v_mov_b32 v24, 0
    v_mov_b32 v25, 0
    v_mov_b32 v26, 0
    v_mov_b32 v27, 0
    v_mov_b32 v28, 0
    v_mov_b32 v29, 0
    v_mov_b32 v30, 0
    v_mov_b32 v31, 0
    s_waitcnt vmcnt(6)
    v_lshlrev_b32 v32, 16, v64
    v_and_b32 v33, 0xffff0000, v64
    v_pk_fma_f32 v[24:25], v[32:33], v[40:41], v[24:25] op_sel:[0,0,0] op_sel_hi:[1,0,1]
    v_lshlrev_b32 v34, 16, v65
    v_and_b32 v35, 0xffff0000, v65
    v_pk_fma_f32 v[26:27], v[34:35], v[40:41], v[26:27] op_sel:[0,0,0] op_sel_hi:[1,0,1]
    v_lshlrev_b32 v32, 16, v66
    v_and_b32 v33, 0xffff0000, v66
    v_pk_fma_f32 v[28:29], v[32:33], v[40:41], v[28:29] op_sel:[0,0,0] op_sel_hi:[1,0,1]
    v_lshlrev_b32 v34, 16, v67
    v_and_b32 v35, 0xffff0000, v67
    v_pk_fma_f32 v[30:31], v[34:35], v[40:41], v[30:31] op_sel:[0,0,0] op_sel_hi:[1,0,1]
    s_waitcnt vmcnt(5)
    v_lshlrev_b32 v32, 16, v68
    v_and_b32 v33, 0xffff0000, v68
    v_pk_fma_f32 v[24:25], v[32:33], v[40:41], v[24:25] op_sel:[0,1,0] op_sel_hi:[1,1,1]
    v_lshlrev_b32 v34, 16, v69
    v_and_b32 v35, 0xffff0000, v69
    v_pk_fma_f32 v[26:27], v[34:35], v[40:41], v[26:27] op_sel:[0,1,0] op_sel_hi:[1,1,1]
    v_lshlrev_b32 v32, 16, v70
    v_and_b32 v33, 0xffff0000, v70
    v_pk_fma_f32 v[28:29], v[32:33], v[40:41], v[28:29] op_sel:[0,1,0] op_sel_hi:[1,1,1]
    v_lshlrev_b32 v34, 16, v71
    v_and_b32 v35, 0xffff0000, v71
    v_pk_fma_f32 v[30:31], v[34:35], v[40:41], v[30:31] op_sel:[0,1,0] op_sel_hi:[1,1,1]
    s_waitcnt vmcnt(4)
    v_lshlrev_b32 v32, 16, v72
    v_and_b32 v33, 0xffff0000, v72
    v_pk_fma_f32 v[24:25], v[32:33], v[42:43], v[24:25] op_sel:[0,0,0] op_sel_hi:[1,0,1]
    v_lshlrev_b32 v34, 16, v73
    v_and_b32 v35, 0xffff0000, v73
    v_pk_fma_f32 v[26:27], v[34:35], v[42:43], v[26:27] op_sel:[0,0,0] op_sel_hi:[1,0,1]
    v_lshlrev_b32 v32, 16, v74
    v_and_b32 v33, 0xffff0000, v74
    v_pk_fma_f32 v[28:29], v[32:33], v[42:43], v[28:29] op_sel:[0,0,0] op_sel_hi:[1,0,1]
    v_lshlrev_b32 v34, 16, v75
    v_and_b32 v35, 0xffff0000, v75
    v_pk_fma_f32 v[30:31], v[34:35], v[42:43], v[30:31] op_sel:[0,0,0] op_sel_hi:[1,0,1]
    s_waitcnt vmcnt(3)
    v_lshlrev_b32 v32, 16, v76
    v_and_b32 v33, 0xffff0000, v76
    v_pk_fma_f32 v[24:25], v[32:33], v[42:43], v[24:25] op_sel:[0,1,0] op_sel_hi:[1,1,1]
    v_lshlrev_b32 v34, 16, v77
    v_and_b32 v35, 0xffff0000, v77
    v_pk_fma_f32 v[26:27], v[34:35], v[42:43], v[26:27] op_sel:[0,1,0] op_sel_hi:[1,1,1]
    v_lshlrev_b32 v32, 16, v78
    v_and_b32 v33, 0xffff0000, v78
    v_pk_fma_f32 v[28:29], v[32:33], v[42:43], v[28:29] op_sel:[0,1,0] op_sel_hi:[1,1,1]
    v_lshlrev_b32 v34, 16, v79
    v_and_b32 v35, 0xffff0000, v79
    v_pk_fma_f32 v[30:31], v[34:35], v[42:43], v[30:31] op_sel:[0,1,0] op_sel_hi:[1,1,1]
    s_waitcnt vmcnt(2)
    v_lshlrev_b32 v32, 16, v80
    v_and_b32 v33, 0xffff0000, v80
    v_pk_fma_f32 v[24:25], v[32:33], v[44:45], v[24:25] op_sel:[0,0,0] op_sel_hi:[1,0,1]
    v_lshlrev_b32 v34, 16, v81
    v_and_b32 v35, 0xffff0000, v81
    v_pk_fma_f32 v[26:27], v[34:35], v[44:45], v[26:27] op_sel:[0,0,0] op_sel_hi:[1,0,1]
    v_lshlrev_b32 v32, 16, v82
    v_and_b32 v33, 0xffff0000, v82
    v_pk_fma_f32 v[28:29], v[32:33], v[44:45], v[28:29] op_sel:[0,0,0] op_sel_hi:[1,0,1]
    v_lshlrev_b32 v34, 16, v83
    v_and_b32 v35, 0xffff0000, v83
    v_pk_fma_f32 v[30:31], v[34:35], v[44:45], v[30:31] op_sel:[0,0,0] op_sel_hi:[1,0,1]
    s_waitcnt vmcnt(1)
    v_lshlrev_b32 v32, 16, v84
    v_and_b32 v33, 0xffff0000, v84
    v_pk_fma_f32 v[24:25], v[32:33], v[44:45], v[24:25] op_sel:[0,1,0] op_sel_hi:[1,1,1]
    v_lshlrev_b32 v34, 16, v85
    v_and_b32 v35, 0xffff0000, v85
    v_pk_fma_f32 v[26:27], v[34:35], v[44:45], v[26:27] op_sel:[0,1,0] op_sel_hi:[1,1,1]
    v_lshlrev_b32 v32, 16, v86
    v_and_b32 v33, 0xffff0000, v86
    v_pk_fma_f32 v[28:29], v[32:33], v[44:45], v[28:29] op_sel:[0,1,0] op_sel_hi:[1,1,1]
    v_lshlrev_b32 v34, 16, v87
    v_and_b32 v35, 0xffff0000, v87
    v_pk_fma_f32 v[30:31], v[34:35], v[44:45], v[30:31] op_sel:[0,1,0] op_sel_hi:[1,1,1]
    s_waitcnt vmcnt(0)
    v_lshlrev_b32 v32, 16, v88
    v_and_b32 v33, 0xffff0000, v88
    v_pk_fma_f32 v[24:25], v[32:33], v[46:47], v[24:25] op_sel:[0,0,0] op_sel_hi:[1,0,1]
    v_lshlrev_b32 v34, 16, v89
    v_and_b32 v35, 0xffff0000, v89
    v_pk_fma_f32 v[26:27], v[34:35], v[46:47], v[26:27] op_sel:[0,0,0] op_sel_hi:[1,0,1]
    v_lshlrev_b32 v32, 16, v90
    v_and_b32 v33, 0xffff0000, v90
    v_pk_fma_f32 v[28:29], v[32:33], v[46:47], v[28:29] op_sel:[0,0,0] op_sel_hi:[1,0,1]
    v_lshlrev_b32 v34, 16, v91
    v_and_b32 v35, 0xffff0000, v91
    v_pk_fma_f32 v[30:31], v[34:35], v[46:47], v[30:31] op_sel:[0,0,0] op_sel_hi:[1,0,1]
    v_add_f32_dpp v24, v24, v24 row_ror:8 row_mask:0xf bank_mask:0xf
    v_add_f32_dpp v25, v25, v25 row_ror:8 row_mask:0xf bank_mask:0xf
    v_add_f32_dpp v26, v26, v26 row_ror:8 row_mask:0xf bank_mask:0xf
    v_add_f32_dpp v27, v27, v27 row_ror:8 row_mask:0xf bank_mask:0xf
    v_add_f32_dpp v28, v28, v28 row_ror:8 row_mask:0xf bank_mask:0xf
    v_add_f32_dpp v29, v29, v29 row_ror:8 row_mask:0xf bank_mask:0xf
    v_add_f32_dpp v30, v30, v30 row_ror:8 row_mask:0xf bank_mask:0xf
    v_add_f32_dpp v31, v31, v31 row_ror:8 row_mask:0xf bank_mask:0xf
    v_mov_b32 v32, v24
    v_mov_b32 v33, v25
    v_mov_b32 v34, v26
    v_mov_b32 v35, v27
    v_mov_b32 v36, v28
    v_mov_b32 v37, v29
    v_mov_b32 v38, v30
    v_mov_b32 v39, v31
    v_permlane16_swap_b32 v24, v32
    v_permlane16_swap_b32 v25, v33
    v_permlane16_swap_b32 v26, v34
    v_permlane16_swap_b32 v27, v35
    v_permlane16_swap_b32 v28, v36
    v_permlane16_swap_b32 v29, v37
    v_permlane16_swap_b32 v30, v38
    v_permlane16_swap_b32 v31, v39
    v_pk_add_f32 v[24:25], v[24:25], v[32:33]
    v_pk_add_f32 v[26:27], v[26:27], v[34:35]
    v_pk_add_f32 v[28:29], v[28:29], v[36:37]
    v_pk_add_f32 v[30:31], v[30:31], v[38:39]
    v_mov_b32 v32, v24
    v_mov_b32 v33, v25
    v_mov_b32 v34, v26
    v_mov_b32 v35, v27
    v_mov_b32 v36, v28
    v_mov_b32 v37, v29
    v_mov_b32 v38, v30
    v_mov_b32 v39, v31
    v_permlane32_swap_b32 v24, v32
    v_permlane32_swap_b32 v25, v33
    v_permlane32_swap_b32 v26, v34
    v_permlane32_swap_b32 v27, v35
    v_permlane32_swap_b32 v28, v36
    v_permlane32_swap_b32 v29, v37
    v_permlane32_swap_b32 v30, v38
    v_permlane32_swap_b32 v31, v39
    v_pk_add_f32 v[24:25], v[24:25], v[32:33]
    v_pk_add_f32 v[26:27], v[26:27], v[34:35]
    v_pk_add_f32 v[28:29], v[28:29], v[36:37]
    v_pk_add_f32 v[30:31], v[30:31], v[38:39]
    s_lshl_b32 s80, s3, 8
    s_add_u32 s80, s80, 4096
    v_lshl_add_u32 v32, v1, 5, s80
    s_mov_b64 exec, 0xff
    ds_write_b128 v32, v[24:27]
    ds_write_b128 v32, v[28:31] offset:16
    s_mov_b64 exec, -1
    v_lshlrev_b32 v32, 3, v1
    s_waitcnt lgkmcnt(0)
    s_barrier
    s_cmp_lg_u32 s3, 0
    s_cbranch_scc1 L_gv2
    s_mov_b32 exec_hi, 0
    ds_read_b64 v[48:49], v32 offset:4096
    ds_read_b64 v[50:51], v32 offset:4352
    ds_read_b64 v[52:53], v32 offset:4608
    ds_read_b64 v[54:55], v32 offset:4864
    ds_read_b64 v[56:57], v32 offset:5120
    ds_read_b64 v[58:59], v32 offset:5376
    ds_read_b64 v[60:61], v32 offset:5632
    ds_read_b64 v[62:63], v32 offset:5888
    s_mul_i32 s80, s66, 9363
    s_lshr_b32 s80, s80, 16
    s_cmp_eq_u32 s80, 1
    s_cselect_b32 s81, 1.0, 0
    s_cmp_eq_u32 s80, 4
    s_cselect_b32 s81, 1.0, s81
    s_waitcnt lgkmcnt(6)
    v_pk_add_f32 v[48:49], v[48:49], v[50:51]
    s_waitcnt lgkmcnt(5)
    v_pk_add_f32 v[48:49], v[48:49], v[52:53]
    s_waitcnt lgkmcnt(4)
    v_pk_add_f32 v[48:49], v[48:49], v[54:55]
    s_waitcnt lgkmcnt(3)
    v_pk_add_f32 v[48:49], v[48:49], v[56:57]
    s_waitcnt lgkmcnt(2)
    v_pk_add_f32 v[48:49], v[48:49], v[58:59]
    s_waitcnt lgkmcnt(1)
    v_pk_add_f32 v[48:49], v[48:49], v[60:61]
    s_waitcnt lgkmcnt(0)
    v_pk_add_f32 v[48:49], v[48:49], v[62:63]
    v_cvt_pk_bf16_f32 v48, v48, v49
    v_and_b32 v49, 0xffff0000, v48
    v_lshlrev_b32 v48, 16, v48
    v_add_f32 v48, s81, v48
    v_add_f32 v49, s81, v49
    v_cvt_pk_bf16_f32 v48, v48, v49
    v_mov_b32 v49, s60
    s_lshl_b32 s80, s66, 8
    s_add_u32 s80, s80, 49152
    buffer_store_dwordx2 v[48:49], v32, s[52:55], s80 offen sc1
    s_mov_b64 exec, -1
L_gv2:
    s_add_u32 s79, s63, 12
    s_cmp_ge_u32 s79, 42
    s_cbranch_scc1 L_sp2
    s_add_u32 s80, s79, 7
    s_cmp_lt_u32 s79, 28
    s_cselect_b32 s80, s80, s79
    s_cmp_lt_u32 s79, 21
    s_cselect_b32 s80, s79, s80
    s_sub_u32 s81, s79, 28
    s_sub_u32 s82, s79, 7
    s_cmp_lt_u32 s81, 7
    s_cselect_b32 s66, s82, s80
    s_lshl_b32 s80, s66, 7
    v_add_u32 v11, s80, v12
    global_load_dwordx4 v[64:67], v11, s[44:45] nt
    v_add_u32 v11, 43008, v11
    global_load_dwordx4 v[68:71], v11, s[44:45] nt
    v_add_u32 v11, 43008, v11
    global_load_dwordx4 v[72:75], v11, s[44:45] nt
    v_add_u32 v11, 43008, v11
    global_load_dwordx4 v[76:79], v11, s[44:45] nt
    v_add_u32 v11, 43008, v11
    global_load_dwordx4 v[80:83], v11, s[44:45] nt
    v_add_u32 v11, 43008, v11
    global_load_dwordx4 v[84:87], v11, s[44:45] nt
    v_add_u32 v11, 43008, v11
    global_load_dwordx4 v[88:91], v11, s[44:45] nt
    v_mov_b32 v24, 0
    v_mov_b32 v25, 0
    v_mov_b32 v26, 0
    v_mov_b32 v27, 0
    v_mov_b32 v28, 0
    v_mov_b32 v29, 0
    v_mov_b32 v30, 0
    v_mov_b32 v31, 0
    s_waitcnt vmcnt(6)
    v_lshlrev_b32 v32, 16, v64
    v_and_b32 v33, 0xffff0000, v64
    v_pk_fma_f32 v[24:25], v[32:33], v[40:41], v[24:25] op_sel:[0,0,0] op_sel_hi:[1,0,1]
    v_lshlrev_b32 v34, 16, v65
    v_and_b32 v35, 0xffff0000, v65
    v_pk_fma_f32 v[26:27], v[34:35], v[40:41], v[26:27] op_sel:[0,0,0] op_sel_hi:[1,0,1]
    v_lshlrev_b32 v32, 16, v66
    v_and_b32 v33, 0xffff0000, v66
    v_pk_fma_f32 v[28:29], v[32:33], v[40:41], v[28:29] op_sel:[0,0,0] op_sel_hi:[1,0,1]
    v_lshlrev_b32 v34, 16, v67
    v_and_b32 v35, 0xffff0000, v67
    v_pk_fma_f32 v[30:31], v[34:35], v[40:41], v[30:31] op_sel:[0,0,0] op_sel_hi:[1,0,1]
    s_waitcnt vmcnt(5)
    v_lshlrev_b32 v32, 16, v68
    v_and_b32 v33, 0xffff0000, v68
    v_pk_fma_f32 v[24:25], v[32:33], v[40:41], v[24:25] op_sel:[0,1,0] op_sel_hi:[1,1,1]
    v_lshlrev_b32 v34, 16, v69
    v_and_b32 v35, 0xffff0000, v69
    v_pk_fma_f32 v[26:27], v[34:35], v[40:41], v[26:27] op_sel:[0,1,0] op_sel_hi:[1,1,1]
    v_lshlrev_b32 v32, 16, v70
    v_and_b32 v33, 0xffff0000, v70
    v_pk_fma_f32 v[28:29], v[32:33], v[40:41], v[28:29] op_sel:[0,1,0] op_sel_hi:[1,1,1]
    v_lshlrev_b32 v34, 16, v71
    v_and_b32 v35, 0xffff0000, v71
    v_pk_fma_f32 v[30:31], v[34:35], v[40:41], v[30:31] op_sel:[0,1,0] op_sel_hi:[1,1,1]
    s_waitcnt vmcnt(4)
    v_lshlrev_b32 v32, 16, v72
    v_and_b32 v33, 0xffff0000, v72
    v_pk_fma_f32 v[24:25], v[32:33], v[42:43], v[24:25] op_sel:[0,0,0] op_sel_hi:[1,0,1]
    v_lshlrev_b32 v34, 16, v73
    v_and_b32 v35, 0xffff0000, v73
    v_pk_fma_f32 v[26:27], v[34:35], v[42:43], v[26:27] op_sel:[0,0,0] op_sel_hi:[1,0,1]
    v_lshlrev_b32 v32, 16, v74
    v_and_b32 v33, 0xffff0000, v74
    v_pk_fma_f32 v[28:29], v[32:33], v[42:43], v[28:29] op_sel:[0,0,0] op_sel_hi:[1,0,1]
    v_lshlrev_b32 v34, 16, v75
    v_and_b32 v35, 0xffff0000, v75
    v_pk_fma_f32 v[30:31], v[34:35], v[42:43], v[30:31] op_sel:[0,0,0] op_sel_hi:[1,0,1]
    s_waitcnt vmcnt(3)
    v_lshlrev_b32 v32, 16, v76
    v_and_b32 v33, 0xffff0000, v76
    v_pk_fma_f32 v[24:25], v[32:33], v[42:43], v[24:25] op_sel:[0,1,0] op_sel_hi:[1,1,1]
    v_lshlrev_b32 v34, 16, v77
    v_and_b32 v35, 0xffff0000, v77
    v_pk_fma_f32 v[26:27], v[34:35], v[42:43], v[26:27] op_sel:[0,1,0] op_sel_hi:[1,1,1]
    v_lshlrev_b32 v32, 16, v78
    v_and_b32 v33, 0xffff0000, v78
    v_pk_fma_f32 v[28:29], v[32:33], v[42:43], v[28:29] op_sel:[0,1,0] op_sel_hi:[1,1,1]
    v_lshlrev_b32 v34, 16, v79
    v_and_b32 v35, 0xffff0000, v79
    v_pk_fma_f32 v[30:31], v[34:35], v[42:43], v[30:31] op_sel:[0,1,0] op_sel_hi:[1,1,1]
    s_waitcnt vmcnt(2)
    v_lshlrev_b32 v32, 16, v80
    v_and_b32 v33, 0xffff0000, v80
    v_pk_fma_f32 v[24:25], v[32:33], v[44:45], v[24:25] op_sel:[0,0,0] op_sel_hi:[1,0,1]
    v_lshlrev_b32 v34, 16, v81
    v_and_b32 v35, 0xffff0000, v81
    v_pk_fma_f32 v[26:27], v[34:35], v[44:45], v[26:27] op_sel:[0,0,0] op_sel_hi:[1,0,1]
    v_lshlrev_b32 v32, 16, v82
    v_and_b32 v33, 0xffff0000, v82
    v_pk_fma_f32 v[28:29], v[32:33], v[44:45], v[28:29] op_sel:[0,0,0] op_sel_hi:[1,0,1]
    v_lshlrev_b32 v34, 16, v83
    v_and_b32 v35, 0xffff0000, v83
    v_pk_fma_f32 v[30:31], v[34:35], v[44:45], v[30:31] op_sel:[0,0,0] op_sel_hi:[1,0,1]
    s_waitcnt vmcnt(1)
    v_lshlrev_b32 v32, 16, v84
    v_and_b32 v33, 0xffff0000, v84
    v_pk_fma_f32 v[24:25], v[32:33], v[44:45], v[24:25] op_sel:[0,1,0] op_sel_hi:[1,1,1]
    v_lshlrev_b32 v34, 16, v85
    v_and_b32 v35, 0xffff0000, v85
    v_pk_fma_f32 v[26:27], v[34:35], v[44:45], v[26:27] op_sel:[0,1,0] op_sel_hi:[1,1,1]
    v_lshlrev_b32 v32, 16, v86
    v_and_b32 v33, 0xffff0000, v86
    v_pk_fma_f32 v[28:29], v[32:33], v[44:45], v[28:29] op_sel:[0,1,0] op_sel_hi:[1,1,1]
    v_lshlrev_b32 v34, 16, v87
    v_and_b32 v35, 0xffff0000, v87
    v_pk_fma_f32 v[30:31], v[34:35], v[44:45], v[30:31] op_sel:[0,1,0] op_sel_hi:[1,1,1]
    s_waitcnt vmcnt(0)
    v_lshlrev_b32 v32, 16, v88
    v_and_b32 v33, 0xffff0000, v88
    v_pk_fma_f32 v[24:25], v[32:33], v[46:47], v[24:25] op_sel:[0,0,0] op_sel_hi:[1,0,1]
    v_lshlrev_b32 v34, 16, v89
    v_and_b32 v35, 0xffff0000, v89
    v_pk_fma_f32 v[26:27], v[34:35], v[46:47], v[26:27] op_sel:[0,0,0] op_sel_hi:[1,0,1]
    v_lshlrev_b32 v32, 16, v90
    v_and_b32 v33, 0xffff0000, v90
    v_pk_fma_f32 v[28:29], v[32:33], v[46:47], v[28:29] op_sel:[0,0,0] op_sel_hi:[1,0,1]
    v_lshlrev_b32 v34, 16, v91
    v_and_b32 v35, 0xffff0000, v91
    v_pk_fma_f32 v[30:31], v[34:35], v[46:47], v[30:31] op_sel:[0,0,0] op_sel_hi:[1,0,1]
    v_add_f32_dpp v24, v24, v24 row_ror:8 row_mask:0xf bank_mask:0xf
    v_add_f32_dpp v25, v25, v25 row_ror:8 row_mask:0xf bank_mask:0xf
    v_add_f32_dpp v26, v26, v26 row_ror:8 row_mask:0xf bank_mask:0xf
    v_add_f32_dpp v27, v27, v27 row_ror:8 row_mask:0xf bank_mask:0xf
    v_add_f32_dpp v28, v28, v28 row_ror:8 row_mask:0xf bank_mask:0xf
    v_add_f32_dpp v29, v29, v29 row_ror:8 row_mask:0xf bank_mask:0xf
    v_add_f32_dpp v30, v30, v30 row_ror:8 row_mask:0xf bank_mask:0xf
    v_add_f32_dpp v31, v31, v31 row_ror:8 row_mask:0xf bank_mask:0xf
    v_mov_b32 v32, v24
    v_mov_b32 v33, v25
    v_mov_b32 v34, v26
    v_mov_b32 v35, v27
    v_mov_b32 v36, v28
    v_mov_b32 v37, v29
    v_mov_b32 v38, v30
    v_mov_b32 v39, v31
    v_permlane16_swap_b32 v24, v32
    v_permlane16_swap_b32 v25, v33
    v_permlane16_swap_b32 v26, v34
    v_permlane16_swap_b32 v27, v35
    v_permlane16_swap_b32 v28, v36
    v_permlane16_swap_b32 v29, v37
    v_permlane16_swap_b32 v30, v38
    v_permlane16_swap_b32 v31, v39
    v_pk_add_f32 v[24:25], v[24:25], v[32:33]
    v_pk_add_f32 v[26:27], v[26:27], v[34:35]
    v_pk_add_f32 v[28:29], v[28:29], v[36:37]
    v_pk_add_f32 v[30:31], v[30:31], v[38:39]
    v_mov_b32 v32, v24
    v_mov_b32 v33, v25
    v_mov_b32 v34, v26
    v_mov_b32 v35, v27
    v_mov_b32 v36, v28
    v_mov_b32 v37, v29
    v_mov_b32 v38, v30
    v_mov_b32 v39, v31
    v_permlane32_swap_b32 v24, v32
    v_permlane32_swap_b32 v25, v33
    v_permlane32_swap_b32 v26, v34
    v_permlane32_swap_b32 v27, v35
    v_permlane32_swap_b32 v28, v36
    v_permlane32_swap_b32 v29, v37
    v_permlane32_swap_b32 v30, v38
    v_permlane32_swap_b32 v31, v39
    v_pk_add_f32 v[24:25], v[24:25], v[32:33]
    v_pk_add_f32 v[26:27], v[26:27], v[34:35]
    v_pk_add_f32 v[28:29], v[28:29], v[36:37]
    v_pk_add_f32 v[30:31], v[30:31], v[38:39]
    s_lshl_b32 s80, s3, 8
    s_add_u32 s80, s80, 6144
    v_lshl_add_u32 v32, v1, 5, s80
    s_mov_b64 exec, 0xff
    ds_write_b128 v32, v[24:27]
    ds_write_b128 v32, v[28:31] offset:16
    s_mov_b64 exec, -1
    v_lshlrev_b32 v32, 3, v1
    s_waitcnt lgkmcnt(0)
    s_barrier
    s_cmp_lg_u32 s3, 0
    s_cbranch_scc1 L_gv3
    s_mov_b32 exec_hi, 0
    ds_read_b64 v[48:49], v32 offset:6144
    ds_read_b64 v[50:51], v32 offset:6400
    ds_read_b64 v[52:53], v32 offset:6656
    ds_read_b64 v[54:55], v32 offset:6912
    ds_read_b64 v[56:57], v32 offset:7168
    ds_read_b64 v[58:59], v32 offset:7424
    ds_read_b64 v[60:61], v32 offset:7680
    ds_read_b64 v[62:63], v32 offset:7936
    s_mul_i32 s80, s66, 9363
    s_lshr_b32 s80, s80, 16
    s_cmp_eq_u32 s80, 1
    s_cselect_b32 s81, 1.0, 0
    s_cmp_eq_u32 s80, 4
    s_cselect_b32 s81, 1.0, s81
    s_waitcnt lgkmcnt(6)
    v_pk_add_f32 v[48:49], v[48:49], v[50:51]
    s_waitcnt lgkmcnt(5)
    v_pk_add_f32 v[48:49], v[48:49], v[52:53]
    s_waitcnt lgkmcnt(4)
    v_pk_add_f32 v[48:49], v[48:49], v[54:55]
    s_waitcnt lgkmcnt(3)
    v_pk_add_f32 v[48:49], v[48:49], v[56:57]
    s_waitcnt lgkmcnt(2)
    v_pk_add_f32 v[48:49], v[48:49], v[58:59]
    s_waitcnt lgkmcnt(1)
    v_pk_add_f32 v[48:49], v[48:49], v[60:61]
    s_waitcnt lgkmcnt(0)
    v_pk_add_f32 v[48:49], v[48:49], v[62:63]
    v_cvt_pk_bf16_f32 v48, v48, v49
    v_and_b32 v49, 0xffff0000, v48
    v_lshlrev_b32 v48, 16, v48
    v_add_f32 v48, s81, v48
    v_add_f32 v49, s81, v49
    v_cvt_pk_bf16_f32 v48, v48, v49
    v_mov_b32 v49, s60
    s_lshl_b32 s80, s66, 8
    s_add_u32 s80, s80, 49152
    buffer_store_dwordx2 v[48:49], v32, s[52:55], s80 offen sc1
    s_mov_b64 exec, -1
L_gv3:
    s_branch L_sp2
L_spw:
    v_lshrrev_b32 v9, 5, v1
    v_bfe_u32 v10, v1, 4, 1
    v_lshl_add_u32 v9, v9, 2, v10
    v_bfe_u32 v10, v1, 2, 2
    v_lshl_add_u32 v9, v9, 2, v10
    v_mul_u32_u24 v9, 896, v9
    v_and_b32 v10, 3, v1
    v_lshl_add_u32 v9, v10, 3, v9
    s_lshr_b32 s80, s3, 2
    s_and_b32 s81, s3, 3
    s_mul_i32 s82, s80, 28672
    s_mul_i32 s83, s81, 224
    s_add_u32 s82, s82, s83
    v_add_u32 v9, s82, v9
    s_lshl_b32 s82, s70, 1
    s_add_u32 s82, s82, s80
    s_lshr_b32 s80, s82, 3
    s_lshl_b32 s80, s80, 2
    s_add_u32 s80, s80, s81
    s_mul_i32 s80, s80, 57344
    s_and_b32 s82, s82, 7
    s_lshl_b32 s82, s82, 10
    s_add_u32 s80, s80, s82
    s_add_u32 s80, s80, 8388608
    s_waitcnt vmcnt(0)
    s_barrier
    ds_read_b64_tr_b16 v[128:129], v9 offset:16384
    ds_read_b64_tr_b16 v[130:131], v9 offset:23552
    ds_read_b64_tr_b16 v[132:133], v9 offset:16416
    ds_read_b64_tr_b16 v[134:135], v9 offset:23584
    ds_read_b64_tr_b16 v[136:137], v9 offset:16448
    ds_read_b64_tr_b16 v[138:139], v9 offset:23616
    ds_read_b64_tr_b16 v[140:141], v9 offset:16480
    ds_read_b64_tr_b16 v[142:143], v9 offset:23648
    ds_read_b64_tr_b16 v[144:145], v9 offset:16512
    ds_read_b64_tr_b16 v[146:147], v9 offset:23680
    ds_read_b64_tr_b16 v[148:149], v9 offset:16544
    ds_read_b64_tr_b16 v[150:151], v9 offset:23712
    ds_read_b64_tr_b16 v[152:153], v9 offset:16576
    ds_read_b64_tr_b16 v[154:155], v9 offset:23744
    s_waitcnt lgkmcnt(12)
    buffer_store_dwordx4 v[128:131], v2, s[52:55], s80 offen sc1
    s_add_u32 s80, s80, 8192
    s_waitcnt lgkmcnt(10)
    buffer_store_dwordx4 v[132:135], v2, s[52:55], s80 offen sc1
    s_add_u32 s80, s80, 8192
    s_waitcnt lgkmcnt(8)
    buffer_store_dwordx4 v[136:139], v2, s[52:55], s80 offen sc1
    s_add_u32 s80, s80, 8192
    s_waitcnt lgkmcnt(6)
    buffer_store_dwordx4 v[140:143], v2, s[52:55], s80 offen sc1
    s_add_u32 s80, s80, 8192
    s_waitcnt lgkmcnt(4)
    buffer_store_dwordx4 v[144:147], v2, s[52:55], s80 offen sc1
    s_add_u32 s80, s80, 8192
    s_waitcnt lgkmcnt(2)
    buffer_store_dwordx4 v[148:151], v2, s[52:55], s80 offen sc1
    s_add_u32 s80, s80, 8192
    s_waitcnt lgkmcnt(0)
    buffer_store_dwordx4 v[152:155], v2, s[52:55], s80 offen sc1
    s_waitcnt vmcnt(0)
    s_barrier
    s_cmp_lg_u32 s3, 0
    s_cbranch_scc1 L_fw
    s_lshr_b32 s80, s63, 3
    s_lshl_b32 s80, s80, 7
    s_and_b32 s81, s63, 7
    s_lshl_b32 s81, s81, 2
    s_add_u32 s80, s80, s81
    v_mov_b32 v10, 512
    v_mov_b32 v11, s60
    s_mov_b64 exec, 1
    buffer_store_dword v11, v10, s[52:55], s80 offen sc1
    s_mov_b64 exec, -1
L_fw:
    s_bitcmp1_b32 s70, 1
    s_cselect_b32 s56, s38, s36
    s_cselect_b32 s57, s39, s37
    s_mov_b32 s58, 1605632
    s_lshr_b32 s80, s70, 2
    s_lshl_b32 s80, s80, 9
    s_lshl_b32 s81, s3, 6
    s_add_u32 s80, s80, s81
    s_and_b32 s81, s70, 1
    s_mul_i32 s81, s81, 802816
    s_add_u32 s80, s80, s81
    s_mul_i32 s71, s3, 14336
    s_add_u32 s71, s71, 16384
    v_lshrrev_b32 v9, 2, v1
    v_mul_u32_u24 v9, 3584, v9
    v_and_b32 v10, 3, v1
    v_lshl_add_u32 v9, v10, 4, v9
    s_add_u32 m0, s71, 0
    s_nop 0
    buffer_load_dwordx4 v9, s[56:59], s80 offen lds
    s_add_u32 s80, s80, 57344
    s_add_u32 m0, s71, 1024
    s_nop 0
    buffer_load_dwordx4 v9, s[56:59], s80 offen lds
    s_add_u32 s80, s80, 57344
    s_add_u32 m0, s71, 2048
    s_nop 0
    buffer_load_dwordx4 v9, s[56:59], s80 offen lds
    s_add_u32 s80, s80, 57344
    s_add_u32 m0, s71, 3072
    s_nop 0
    buffer_load_dwordx4 v9, s[56:59], s80 offen lds
    s_add_u32 s80, s80, 57344
    s_add_u32 m0, s71, 4096
    s_nop 0
    buffer_load_dwordx4 v9, s[56:59], s80 offen lds
    s_add_u32 s80, s80, 57344
    s_add_u32 m0, s71, 5120
    s_nop 0
    buffer_load_dwordx4 v9, s[56:59], s80 offen lds
    s_add_u32 s80, s80, 57344
    s_add_u32 m0, s71, 6144
    s_nop 0
    buffer_load_dwordx4 v9, s[56:59], s80 offen lds
    s_add_u32 s80, s80, 57344
    s_add_u32 m0, s71, 7168
    s_nop 0
    buffer_load_dwordx4 v9, s[56:59], s80 offen lds
    s_add_u32 s80, s80, 57344
    s_add_u32 m0, s71, 8192
    s_nop 0
    buffer_load_dwordx4 v9, s[56:59], s80 offen lds
    s_add_u32 s80, s80, 57344
    s_add_u32 m0, s71, 9216
    s_nop 0
    buffer_load_dwordx4 v9, s[56:59], s80 offen lds
    s_add_u32 s80, s80, 57344
    s_add_u32 m0, s71, 10240
    s_nop 0
    buffer_load_dwordx4 v9, s[56:59], s80 offen lds
    s_add_u32 s80, s80, 57344
    s_add_u32 m0, s71, 11264
    s_nop 0
    buffer_load_dwordx4 v9, s[56:59], s80 offen lds
    s_add_u32 s80, s80, 57344
    s_add_u32 m0, s71, 12288
    s_nop 0
    buffer_load_dwordx4 v9, s[56:59], s80 offen lds
    s_add_u32 s80, s80, 57344
    s_add_u32 m0, s71, 13312
    s_nop 0
    buffer_load_dwordx4 v9, s[56:59], s80 offen lds
    s_waitcnt vmcnt(0) lgkmcnt(0)
    v_min_u32 v12, 447, v0
    v_lshlrev_b32 v11, 3, v12
    s_mov_b32 s80, 54528
    s_mov_b32 s87, 0
L_poll8:
    buffer_load_dwordx2 v[14:15], v11, s[52:55], s80 offen sc1
    s_waitcnt vmcnt(0)
    v_cmp_ne_u32 vcc, s60, v15
    s_nop 4
    s_cbranch_vccz L_pdone8
    s_sleep 4
    s_add_u32 s87, s87, 1
    s_cmp_lt_u32 s87, 20000
    s_cbranch_scc1 L_poll8
L_pdone8:
    v_lshlrev_b32 v12, 2, v12
    ds_write_b32 v12, v14 offset:8192
    s_lshr_b32 s81, s70, 2
    s_lshl_b32 s81, s81, 3
    s_add_u32 s81, s81, s3
    s_lshl_b32 s81, s81, 11
    s_bfe_u32 s82, s70, 0x10001
    s_lshl_b32 s82, s82, 10
    s_add_u32 s81, s81, s82
    s_and_b32 s82, s70, 1
    s_lshl_b32 s83, s82, 9
    s_add_u32 s83, s83, s81
    s_add_u32 s83, s83, 4718592
    v_lshrrev_b32 v9, 5, v1
    v_bfe_u32 v10, v1, 2, 2
    v_lshl_add_u32 v9, v9, 3, v10
    v_lshlrev_b32 v9, 6, v9
    v_bfe_u32 v10, v1, 4, 1
    v_lshl_add_u32 v9, v10, 5, v9
    v_and_b32 v10, 3, v1
    v_lshl_add_u32 v9, v10, 3, v9
    v_add_u32 v9, s71, v9
    ds_read_b64_tr_b16 v[128:129], v9 offset:0
    ds_read_b64_tr_b16 v[130:131], v9 offset:256
    ds_read_b64_tr_b16 v[132:133], v9 offset:1024
    ds_read_b64_tr_b16 v[134:135], v9 offset:1280
    ds_read_b64_tr_b16 v[136:137], v9 offset:2048
    ds_read_b64_tr_b16 v[138:139], v9 offset:2304
    ds_read_b64_tr_b16 v[140:141], v9 offset:3072
    ds_read_b64_tr_b16 v[142:143], v9 offset:3328
    ds_read_b64_tr_b16 v[144:145], v9 offset:4096
    ds_read_b64_tr_b16 v[146:147], v9 offset:4352
    ds_read_b64_tr_b16 v[148:149], v9 offset:5120
    ds_read_b64_tr_b16 v[150:151], v9 offset:5376
    ds_read_b64_tr_b16 v[152:153], v9 offset:6144
    ds_read_b64_tr_b16 v[154:155], v9 offset:6400
    ds_read_b64_tr_b16 v[156:157], v9 offset:7168
    ds_read_b64_tr_b16 v[158:159], v9 offset:7424
    ds_read_b64_tr_b16 v[160:161], v9 offset:8192
    ds_read_b64_tr_b16 v[162:163], v9 offset:8448
    ds_read_b64_tr_b16 v[164:165], v9 offset:9216
    ds_read_b64_tr_b16 v[166:167], v9 offset:9472
    ds_read_b64_tr_b16 v[168:169], v9 offset:10240
    ds_read_b64_tr_b16 v[170:171], v9 offset:10496
    ds_read_b64_tr_b16 v[172:173], v9 offset:11264
    ds_read_b64_tr_b16 v[174:175], v9 offset:11520
    ds_read_b64_tr_b16 v[176:177], v9 offset:12288
    ds_read_b64_tr_b16 v[178:179], v9 offset:12544
    ds_read_b64_tr_b16 v[180:181], v9 offset:13312
    ds_read_b64_tr_b16 v[182:183], v9 offset:13568
    v_lshrrev_b32 v13, 5, v1
    v_and_b32 v14, 31, v1
    v_lshlrev_b32 v12, 4, v13
    v_add_u32 v11, 896, v12
    v_cmp_eq_u32 vcc, 0, v14
    s_nop 1
    v_cndmask_b32 v12, v12, v11, vcc
    s_mul_i32 s80, s82, 448
    v_add_u32 v12, s80, v12
    s_waitcnt lgkmcnt(0)
    s_barrier
    ds_read_b128 v[16:19], v12 offset:8192
    ds_read_b128 v[20:23], v12 offset:8224
    ds_read_b128 v[24:27], v12 offset:8256
    ds_read_b128 v[28:31], v12 offset:8288
    ds_read_b128 v[32:35], v12 offset:8320
    ds_read_b128 v[36:39], v12 offset:8352
    ds_read_b128 v[40:43], v12 offset:8384
    ds_read_b128 v[44:47], v12 offset:8416
    ds_read_b128 v[48:51], v12 offset:8448
    ds_read_b128 v[52:55], v12 offset:8480
    ds_read_b128 v[56:59], v12 offset:8512
    ds_read_b128 v[60:63], v12 offset:8544
    ds_read_b128 v[64:67], v12 offset:8576
    ds_read_b128 v[68:71], v12 offset:8608
    s_waitcnt lgkmcnt(13)
    v_mfma_f32_32x32x16_bf16 v[192:207], v[128:131], v[16:19], 0
    s_waitcnt lgkmcnt(12)
    v_mfma_f32_32x32x16_bf16 v[192:207], v[132:135], v[20:23], v[192:207]
    s_waitcnt lgkmcnt(11)
    v_mfma_f32_32x32x16_bf16 v[192:207], v[136:139], v[24:27], v[192:207]
    s_waitcnt lgkmcnt(10)
    v_mfma_f32_32x32x16_bf16 v[192:207], v[140:143], v[28:31], v[192:207]
    s_waitcnt lgkmcnt(9)
    v_mfma_f32_32x32x16_bf16 v[192:207], v[144:147], v[32:35], v[192:207]
    s_waitcnt lgkmcnt(8)
    v_mfma_f32_32x32x16_bf16 v[192:207], v[148:151], v[36:39], v[192:207]
    s_waitcnt lgkmcnt(7)
    v_mfma_f32_32x32x16_bf16 v[192:207], v[152:155], v[40:43], v[192:207]
    s_waitcnt lgkmcnt(6)
    v_mfma_f32_32x32x16_bf16 v[192:207], v[156:159], v[44:47], v[192:207]
    s_waitcnt lgkmcnt(5)
    v_mfma_f32_32x32x16_bf16 v[192:207], v[160:163], v[48:51], v[192:207]
    s_waitcnt lgkmcnt(4)
    v_mfma_f32_32x32x16_bf16 v[192:207], v[164:167], v[52:55], v[192:207]
    s_waitcnt lgkmcnt(3)
    v_mfma_f32_32x32x16_bf16 v[192:207], v[168:171], v[56:59], v[192:207]
    s_waitcnt lgkmcnt(2)
    v_mfma_f32_32x32x16_bf16 v[192:207], v[172:175], v[60:63], v[192:207]
    s_waitcnt lgkmcnt(1)
    v_mfma_f32_32x32x16_bf16 v[192:207], v[176:179], v[64:67], v[192:207]
    s_waitcnt lgkmcnt(0)
    v_mfma_f32_32x32x16_bf16 v[192:207], v[180:183], v[68:71], v[192:207]
    s_lshl_b32 s80, s3, 8
    v_lshlrev_b32 v8, 7, v14
    v_lshl_add_u32 v8, v13, 4, v8
    v_add_u32 v8, s80, v8
    v_lshl_add_u32 v9, v14, 2, s80
    v_cmp_gt_u32 vcc, 2, v14
    s_nop 0
    s_and_saveexec_b64 s[84:85], vcc
    s_nop 3
    ds_write_b128 v8, v[192:195] offset:0
    ds_write_b128 v8, v[196:199] offset:32
    ds_write_b128 v8, v[200:203] offset:64
    ds_write_b128 v8, v[204:207] offset:96
    s_mov_b64 exec, -1
    ds_read_b32 v16, v9
    ds_read_b32 v18, v9 offset:128
    v_mov_b32 v17, s60
    v_mov_b32 v19, s60
    s_waitcnt lgkmcnt(1)
    v_cvt_pk_bf16_f32 v20, v16, v16
    v_lshlrev_b32 v20, 16, v20
    v_sub_f32 v21, v16, v20
    v_cvt_pk_bf16_f32 v16, v20, v21
    s_waitcnt lgkmcnt(0)
    v_cvt_pk_bf16_f32 v20, v18, v18
    v_lshlrev_b32 v20, 16, v20
    v_sub_f32 v21, v18, v20
    v_cvt_pk_bf16_f32 v18, v20, v21
    s_mov_b32 exec_hi, 0
    buffer_store_dwordx4 v[16:19], v2, s[52:55], s83 offen sc1
    s_mov_b64 exec, -1
L_sp2:
    s_waitcnt vmcnt(0) lgkmcnt(0)
    s_lshl_b32 s64, s61, 2
    s_add_u32 s64, s64, s62
    s_sub_u32 s64, s64, 28
    v_lshrrev_b32 v4, 3, v1
    v_and_b32 v5, 7, v1
    v_and_b32 v6, 2, v4
    s_and_b32 s81, s3, 1
    v_or_b32 v6, s81, v6
    v_lshlrev_b32 v6, 1, v6
    v_xor_b32 v5, v5, v6
    v_lshlrev_b32 v5, 4, v5
    v_lshl_add_u32 v4, v4, 12, v5
    v_bfe_u32 v6, v1, 2, 2
    v_lshrrev_b32 v7, 4, v1
    v_lshl_add_u32 v5, v7, 3, v6
    v_lshlrev_b32 v5, 7, v5
    v_and_b32 v6, 2, v6
    v_and_b32 v7, 1, v7
    v_or_b32 v6, v6, v7
    v_lshl_add_u32 v5, v6, 5, v5
    v_and_b32 v6, 3, v1
    v_lshl_add_u32 v5, v6, 3, v5
    s_and_b32 s81, s3, 3
    s_lshl_b32 s81, s81, 5
    v_xor_b32 v9, s81, v5
    s_lshr_b32 s81, s3, 2
    s_lshl_b32 s81, s81, 12
    v_add_u32 v9, s81, v9
    v_mov_b32 v10, 0
    v_mov_b32 v11, 0
    v_mov_b32 v3, 0x3f803f80
    s_lshl_b32 s84, s3, 15
    s_lshl_b32 s82, s64, 7
    s_add_u32 s84, s84, s82
    s_add_u32 s84, s84, 1048576
    s_lshl_b32 s86, s3, 10
    s_cmp_lg_u32 s3, 0
    s_cbranch_scc1 L_sp4
    v_mov_b32 v13, 0
    s_mov_b32 s87, 0
L_poll9:
    buffer_load_dword v14, v13, s[52:55], 0 offen sc1
    s_waitcnt vmcnt(0)
    v_cmp_ne_u32 vcc, s60, v14
    s_nop 4
    s_cbranch_vccz L_pdone9
    s_sleep 2
    s_add_u32 s87, s87, 1
    s_cmp_lt_u32 s87, 20000
    s_cbranch_scc1 L_poll9
L_pdone9:
L_sp4:
    s_barrier
    s_add_u32 m0, s86, 0
    s_nop 0
    buffer_load_dwordx4 v4, s[52:55], s84 offen sc1 lds
    s_add_u32 s84, s84, 262144
    s_add_u32 m0, s86, 8192
    s_nop 0
    buffer_load_dwordx4 v4, s[52:55], s84 offen sc1 lds
    s_add_u32 s84, s84, 262144
    s_add_u32 m0, s86, 16384
    s_nop 0
    buffer_load_dwordx4 v4, s[52:55], s84 offen sc1 lds
    s_add_u32 s84, s84, 262144
    s_add_u32 m0, s86, 24576
    s_nop 0
    buffer_load_dwordx4 v4, s[52:55], s84 offen sc1 lds
    s_add_u32 s84, s84, 262144
    s_add_u32 m0, s86, 32768
    s_nop 0
    buffer_load_dwordx4 v4, s[52:55], s84 offen sc1 lds
    s_add_u32 s84, s84, 262144
    s_add_u32 m0, s86, 40960
    s_nop 0
    buffer_load_dwordx4 v4, s[52:55], s84 offen sc1 lds
    s_add_u32 s84, s84, 262144
    s_add_u32 m0, s86, 49152
    s_nop 0
    buffer_load_dwordx4 v4, s[52:55], s84 offen sc1 lds
    s_waitcnt vmcnt(0)
    s_barrier
    ds_read_b64_tr_b16 v[16:17], v9 offset:0
    ds_read_b64_tr_b16 v[18:19], v9 offset:512
    ds_read_b64_tr_b16 v[20:21], v9 offset:8192
    ds_read_b64_tr_b16 v[22:23], v9 offset:8704
    ds_read_b64_tr_b16 v[24:25], v9 offset:16384
    ds_read_b64_tr_b16 v[26:27], v9 offset:16896
    ds_read_b64_tr_b16 v[28:29], v9 offset:24576
    ds_read_b64_tr_b16 v[30:31], v9 offset:25088
    ds_read_b64_tr_b16 v[32:33], v9 offset:32768
    ds_read_b64_tr_b16 v[34:35], v9 offset:33280
    ds_read_b64_tr_b16 v[36:37], v9 offset:40960
    ds_read_b64_tr_b16 v[38:39], v9 offset:41472
    ds_read_b64_tr_b16 v[40:41], v9 offset:49152
    ds_read_b64_tr_b16 v[42:43], v9 offset:49664
    s_waitcnt lgkmcnt(13)
    v_dot2c_f32_bf16 v10, v16, v3
    v_dot2c_f32_bf16 v11, v16, v16
    v_dot2c_f32_bf16 v10, v17, v3
    v_dot2c_f32_bf16 v11, v17, v17
    s_waitcnt lgkmcnt(12)
    v_dot2c_f32_bf16 v10, v18, v3
    v_dot2c_f32_bf16 v11, v18, v18
    v_dot2c_f32_bf16 v10, v19, v3
    v_dot2c_f32_bf16 v11, v19, v19
    s_waitcnt lgkmcnt(11)
    v_dot2c_f32_bf16 v10, v20, v3
    v_dot2c_f32_bf16 v11, v20, v20
    v_dot2c_f32_bf16 v10, v21, v3
    v_dot2c_f32_bf16 v11, v21, v21
    s_waitcnt lgkmcnt(10)
    v_dot2c_f32_bf16 v10, v22, v3
    v_dot2c_f32_bf16 v11, v22, v22
    v_dot2c_f32_bf16 v10, v23, v3
    v_dot2c_f32_bf16 v11, v23, v23
    s_waitcnt lgkmcnt(9)
    v_dot2c_f32_bf16 v10, v24, v3
    v_dot2c_f32_bf16 v11, v24, v24
    v_dot2c_f32_bf16 v10, v25, v3
    v_dot2c_f32_bf16 v11, v25, v25
    s_waitcnt lgkmcnt(8)
    v_dot2c_f32_bf16 v10, v26, v3
    v_dot2c_f32_bf16 v11, v26, v26
    v_dot2c_f32_bf16 v10, v27, v3
    v_dot2c_f32_bf16 v11, v27, v27
    s_waitcnt lgkmcnt(7)
    v_dot2c_f32_bf16 v10, v28, v3
    v_dot2c_f32_bf16 v11, v28, v28
    v_dot2c_f32_bf16 v10, v29, v3
    v_dot2c_f32_bf16 v11, v29, v29
    s_waitcnt lgkmcnt(6)
    v_dot2c_f32_bf16 v10, v30, v3
    v_dot2c_f32_bf16 v11, v30, v30
    v_dot2c_f32_bf16 v10, v31, v3
    v_dot2c_f32_bf16 v11, v31, v31
    s_waitcnt lgkmcnt(5)
    v_dot2c_f32_bf16 v10, v32, v3
    v_dot2c_f32_bf16 v11, v32, v32
    v_dot2c_f32_bf16 v10, v33, v3
    v_dot2c_f32_bf16 v11, v33, v33
    s_waitcnt lgkmcnt(4)
    v_dot2c_f32_bf16 v10, v34, v3
    v_dot2c_f32_bf16 v11, v34, v34
    v_dot2c_f32_bf16 v10, v35, v3
    v_dot2c_f32_bf16 v11, v35, v35
    s_waitcnt lgkmcnt(3)
    v_dot2c_f32_bf16 v10, v36, v3
    v_dot2c_f32_bf16 v11, v36, v36
    v_dot2c_f32_bf16 v10, v37, v3
    v_dot2c_f32_bf16 v11, v37, v37
    s_waitcnt lgkmcnt(2)
    v_dot2c_f32_bf16 v10, v38, v3
    v_dot2c_f32_bf16 v11, v38, v38
    v_dot2c_f32_bf16 v10, v39, v3
    v_dot2c_f32_bf16 v11, v39, v39
    s_waitcnt lgkmcnt(1)
    v_dot2c_f32_bf16 v10, v40, v3
    v_dot2c_f32_bf16 v11, v40, v40
    v_dot2c_f32_bf16 v10, v41, v3
    v_dot2c_f32_bf16 v11, v41, v41
    s_waitcnt lgkmcnt(0)
    v_dot2c_f32_bf16 v10, v42, v3
    v_dot2c_f32_bf16 v11, v42, v42
    v_dot2c_f32_bf16 v10, v43, v3
    v_dot2c_f32_bf16 v11, v43, v43
    s_nop 1
    v_mov_b32 v12, v10
    v_mov_b32 v13, v11
    s_nop 0
    v_permlane16_swap_b32 v10, v12
    v_permlane16_swap_b32 v11, v13
    v_pk_add_f32 v[10:11], v[10:11], v[12:13]
    v_mov_b32 v12, v10
    v_mov_b32 v13, v11
    s_nop 0
    v_permlane32_swap_b32 v10, v12
    v_permlane32_swap_b32 v11, v13
    v_pk_add_f32 v[10:11], v[10:11], v[12:13]
    v_lshlrev_b32 v14, 3, v1
    v_and_b32 v15, 127, v14
    s_lshl_b32 s81, s3, 7
    v_add_u32 v15, s81, v15
    ds_write_b64 v15, v[10:11] offset:57344
    s_waitcnt lgkmcnt(0)
    s_barrier
    s_cmp_lg_u32 s3, 0
    s_cbranch_scc1 L_spend
    ds_read_b64 v[10:11], v14 offset:57344
    ds_read_b64 v[12:13], v14 offset:57856
    s_waitcnt lgkmcnt(0)
    v_pk_add_f32 v[10:11], v[10:11], v[12:13]
    v_mul_f32 v10, 0x3b124925, v10
    v_mul_f32 v11, 0x3b124925, v11
    v_fma_f32 v11, -v10, v10, v11
    v_max_f32 v11, 0, v11
    v_cvt_pk_bf16_f32 v11, v11, v11
    v_lshlrev_b32 v11, 16, v11
    v_add_f32 v11, 0x3727c5ac, v11
    v_cvt_pk_bf16_f32 v11, v11, v11
    v_lshlrev_b32 v11, 16, v11
    v_sqrt_f32 v11, v11
    s_lshl_b32 s81, s64, 9
    s_add_u32 s81, s81, 65536
    v_cvt_pk_bf16_f32 v10, -v10, v11
    v_mov_b32 v11, s60
    buffer_store_dwordx2 v[10:11], v14, s[52:55], s81 offen sc1
L_spend:
L_end:
    s_endpgm
.section .rodata,"a"
.p2align 6
.amdhsa_kernel adaLN_cond__ssm_conv_s4__glu_gated_bilinear__prompt_kernel
  .amdhsa_next_free_vgpr 256
  .amdhsa_next_free_sgpr 102
  .amdhsa_accum_offset 256
  .amdhsa_group_segment_fixed_size 0
  .amdhsa_kernarg_size 144
  .amdhsa_user_sgpr_count 2
  .amdhsa_user_sgpr_kernarg_segment_ptr 1
  .amdhsa_system_sgpr_workgroup_id_x 1
.end_amdhsa_kernel
```
